```python
import torch

def _softmax(x, axis=-1):
    return torch.softmax(x, dim=axis)
def _gelu(x):
    return torch.nn.functional.gelu(x, approximate="tanh")
def _silu(x):
    return torch.nn.functional.silu(x)
def _sigmoid(x):
    return torch.sigmoid(x)
def _layernorm(x, axis=-1, eps=1e-5):
    m = x.mean(dim=axis, keepdim=True)
    v = x.var(dim=axis, keepdim=True, unbiased=False)
    return (x - m) / torch.sqrt(v + eps)
def _scatter_add(tgt, idx, src, axis=0):
    return tgt.clone().index_add_(axis, idx, src)
def _segment_sum(src, seg, n):
    out = torch.zeros((n,) + src.shape[1:], dtype=src.dtype)
    return out.index_add_(0, seg, src)
def _pad(x, pw):
    flat = tuple(v for pair in reversed(pw) for v in pair)
    return torch.nn.functional.pad(x, flat)

kernel_name = 'recurrent_scan__gqa_block_cached__glu_gated_geglu__decode'

def setup_inputs():

    _w = (lambda a: (lambda t: t.to(torch.bfloat16) if t.is_floating_point() else t)(torch.as_tensor(a)))
    def _A_setup():
        B, Sq, D = 1, 1, 1024
        Hq, Hkv, Sk, Dh = 32, 4, 65536, 128
        assert Hq % Hkv == 0, (Hq, Hkv)
        return {
            "x": _w((lambda *s: torch.randn(*s, dtype=torch.bfloat16) * 0.4)(B, Sq, D)),
            "k_cache": _w((lambda *s: torch.randn(*s, dtype=torch.bfloat16) * 1.6)(B, Hkv, Sk, Dh)),
            "v_cache": _w((lambda *s: torch.randn(*s, dtype=torch.bfloat16) * 1.6)(B, Hkv, Sk, Dh)),
            "wq": _w((lambda *s: torch.randn(*s, dtype=torch.bfloat16) * 1.6)(D, Hq * Dh) * (D ** -0.5)),
            "wo": _w((lambda *s: torch.randn(*s, dtype=torch.bfloat16) * 1.6)(Hq * Dh, D) * ((Hq * Dh) ** -0.5)),
        }
    _A_in = _A_setup()

    def _B_setup():
        B, S, Dm, Df = 1, 1, 1024, 3584
        return {
            "x": _w((lambda *s: torch.randn(*s, dtype=torch.bfloat16) * 0.4)(B, S, Dm)),
            "w_gate": _w((lambda *s: torch.randn(*s, dtype=torch.bfloat16) * 1.6)(Dm, Df) * (Dm ** -0.5)),
            "w_up": _w((lambda *s: torch.randn(*s, dtype=torch.bfloat16) * 1.6)(Dm, Df) * (Dm ** -0.5)),
            "w_down": _w((lambda *s: torch.randn(*s, dtype=torch.bfloat16) * 1.6)(Df, Dm) * (Df ** -0.5)),
        }
    _B_in = _B_setup()

    return {
        "A_x": _A_in["x"],
        "A_k_cache": _A_in["k_cache"],
        "A_v_cache": _A_in["v_cache"],
        "A_wq": _A_in["wq"],
        "A_wo": _A_in["wo"],
        "B_x": _B_in["x"],
        "B_w_gate": _B_in["w_gate"],
        "B_w_up": _B_in["w_up"],
        "B_w_down": _B_in["w_down"],
    }

def reference(A_x, A_k_cache, A_v_cache, A_wq, A_wo, B_x, B_w_gate, B_w_up, B_w_down):
    def _A_ref(x, k_cache, v_cache, wq, wo):
        B, Sq, D = x.shape
        Hq, Dh = 32, 128
        Hkv = k_cache.shape[1]
        rep = Hq // Hkv
        q = (lambda x, *d: x.permute(*d))((x @ wq).reshape(B, Sq, Hq, Dh), 0, 2, 1, 3)
        k = (lambda x, n, axis: torch.repeat_interleave(x, n, dim=axis))(k_cache, rep, axis=1)
        v = (lambda x, n, axis: torch.repeat_interleave(x, n, dim=axis))(v_cache, rep, axis=1)
        scores = torch.einsum("bhqd,bhkd->bhqk", q, k) * (Dh ** -0.5)
        p = _softmax(scores, axis=-1)
        o = torch.einsum("bhqk,bhkd->bhqd", p, v)
        return (lambda x, *d: x.permute(*d))(o, 0, 2, 1, 3).reshape(B, Sq, Hq * Dh) @ wo

    def _B_ref(x, w_gate, w_up, w_down):
        g = torch.einsum("bsd,df->bsf", x, w_gate)
        u = torch.einsum("bsd,df->bsf", x, w_up)
        h = _gelu(g) * u
        return torch.einsum("bsf,fd->bsd", h, w_down)

    x = A_x
    xn = _layernorm(x, axis=-1)
    s = _A_ref(xn, A_k_cache, A_v_cache, A_wq, A_wo)
    g = _silu(_B_ref(xn, B_w_gate, B_w_up, B_w_down))
    return x + s * g
```

```asm
; @launch grid=(256,1,1) block=(448,1,1) lds=155904
.amdgcn_target "amdgcn-amd-amdhsa--gfx950"
.text
.globl recurrent_scan__gqa_block_cached__glu_gated_geglu__decode_kernel
.p2align 8
.type recurrent_scan__gqa_block_cached__glu_gated_geglu__decode_kernel,@function
recurrent_scan__gqa_block_cached__glu_gated_geglu__decode_kernel:
    s_cmpk_ge_u32 s2, 256
    s_cbranch_scc1 L_end
    s_load_dwordx16 s[4:19], s[0:1], 0
    s_load_dwordx8 s[20:27], s[0:1], 64
    v_readfirstlane_b32 s3, v0
    v_and_b32 v1, 63, v0
    v_mov_b32 v2, 131072
    s_mov_b32 s47, 0
    s_and_b32 s58, s2, 7
    s_lshr_b32 s59, s2, 3
    s_lshr_b32 s3, s3, 6
    s_cbranch_scc1 L_notloader
    s_setprio 3
    v_lshrrev_b32 v4, 3, v1
    v_and_b32 v5, 7, v1
    v_lshlrev_b32 v4, 13, v4
    v_lshl_add_u32 v4, v5, 4, v4
    s_and_b32 s62, s2, 3
    s_lshl_b32 s62, s62, 21
    s_lshr_b32 s44, s2, 2
    s_lshl_b32 s44, s44, 7
    s_add_u32 s62, s62, s44
    s_mov_b32 s60, 0
    s_movk_i32 s61, 128
    s_mov_b32 m0, 0
    s_waitcnt lgkmcnt(0)
    s_mov_b64 s[28:29], s[10:11]
    s_mov_b32 s30, 8388608
    s_mov_b32 s31, 0x20000
Lph1:
    buffer_load_dwordx4 v4, s[28:31], s62 offen offset:0 sc1 nt lds
    s_add_u32 s62, s62, 64512
    buffer_load_dwordx4 v4, s[28:31], s62 offen offset:1024 sc1 nt lds
    s_add_u32 s62, s62, 64512
    buffer_load_dwordx4 v4, s[28:31], s62 offen offset:2048 sc1 nt lds
    s_add_u32 s62, s62, 64512
    buffer_load_dwordx4 v4, s[28:31], s62 offen offset:3072 sc1 nt lds
    s_add_u32 s62, s62, 68608
    s_add_u32 s60, s60, 4
    s_lshl_b32 s44, s60, 10
    s_and_b32 m0, s44, 0x1ffff
    s_cmp_lt_u32 s60, 28
    s_cbranch_scc1 Lph1
    v_lshlrev_b32 v5, 4, v1
    v_mov_b32 v6, 0x40000000
    v_cmp_gt_u32 vcc, 56, v1
    s_nop 1
    v_cndmask_b32 v5, v6, v5, vcc
    v_lshrrev_b32 v12, 4, v1
    v_and_b32 v13, 15, v1
    v_lshlrev_b32 v14, 1, v12
    v_xor_b32 v13, v13, v14
    v_lshlrev_b32 v13, 4, v13
    v_lshlrev_b32 v16, 2, v1
    v_add_u32 v16, 155648, v16
    v_cmp_eq_u32 vcc, 0, v1
    s_nop 1
    v_cndmask_b32 v16, v16, v2, vcc
    v_lshl_add_u32 v6, v12, 8, v13
    v_xor_b32 v7, 0x80, v6
    v_lshl_add_u32 v14, v12, 11, v13
    v_xor_b32 v15, 0x80, v14
    s_cmpk_ge_u32 s2, 128
    s_cselect_b64 s[32:33], s[18:19], s[16:17]
    s_mov_b32 s34, 7340032
    s_mov_b32 s35, 0x20000
    s_barrier
Lph2:
    s_sub_u32 s44, s60, 24
    v_mov_b32 v3, s44
    s_waitcnt vmcnt(27)
    buffer_load_dwordx4 v4, s[28:31], s62 offen offset:0 sc1 nt lds
    s_add_u32 s62, s62, 64512
    s_waitcnt vmcnt(27)
    buffer_load_dwordx4 v4, s[28:31], s62 offen offset:1024 sc1 nt lds
    s_add_u32 s62, s62, 64512
    s_waitcnt vmcnt(27)
    buffer_load_dwordx4 v4, s[28:31], s62 offen offset:2048 sc1 nt lds
    s_add_u32 s62, s62, 64512
    s_waitcnt vmcnt(27)
    ds_write_b32 v16, v3 offset:0
    buffer_load_dwordx4 v4, s[28:31], s62 offen offset:3072 sc1 nt lds
    s_add_u32 s62, s62, 68608
    s_add_u32 s60, s60, 4
    s_lshl_b32 s44, s60, 10
    s_and_b32 m0, s44, 0x1ffff
    s_cmp_lt_u32 s60, 32
    s_cbranch_scc1 Lph2
    s_and_b32 s62, s59, 15
    s_mul_i32 s62, s62, 458752
    s_mul_i32 s44, s58, 896
    s_add_u32 s62, s62, s44
Lph3:
    s_sub_u32 s44, s60, 24
    v_mov_b32 v3, s44
    s_waitcnt vmcnt(27)
    buffer_load_dwordx4 v5, s[32:35], s62 offen offset:0 sc1 nt lds
    s_add_u32 s62, s62, 6144
    s_waitcnt vmcnt(27)
    buffer_load_dwordx4 v5, s[32:35], s62 offen offset:1024 sc1 nt lds
    s_add_u32 s62, s62, 6144
    s_waitcnt vmcnt(27)
    buffer_load_dwordx4 v5, s[32:35], s62 offen offset:2048 sc1 nt lds
    s_add_u32 s62, s62, 6144
    s_waitcnt vmcnt(27)
    ds_write_b32 v16, v3 offset:0
    buffer_load_dwordx4 v5, s[32:35], s62 offen offset:3072 sc1 nt lds
    s_add_u32 s62, s62, 10240
    s_add_u32 s60, s60, 4
    s_lshl_b32 s44, s60, 10
    s_and_b32 m0, s44, 0x1ffff
    s_cmp_lt_u32 s60, 96
    s_cbranch_scc1 Lph3
    s_mov_b64 s[28:29], s[6:7]
    s_mov_b32 s30, 67108864
    s_mov_b32 s31, 0x20000
    s_lshl_b32 s62, s2, 18
    s_movk_i32 s63, 352
    ds_read_b32 v12, v2 offset:12
L_kv:
    s_add_u32 s64, s60, 16
    s_waitcnt lgkmcnt(0)
    v_readfirstlane_b32 s65, v12
    ds_read_b32 v12, v2 offset:12
    s_nop 0
    s_cmp_lg_u32 s65, 0
    s_cbranch_scc1 L_lv1
Lph4:
    s_add_u32 s44, s60, 4
Lre5:
    s_cmp_le_u32 s44, s61
    s_cbranch_scc1 Lok5
    ds_read_b128 v[8:11], v2 offset:16
    s_waitcnt lgkmcnt(0)
    v_min_u32 v8, v8, v9
    v_min3_u32 v8, v8, v10, v11
    s_nop 0
    v_readfirstlane_b32 s61, v8
    s_nop 1
    s_add_u32 s61, s61, 128
    s_add_u32 s47, s47, 1
    s_cmp_ge_u32 s47, 2000000
    s_cbranch_scc1 Lok5
    s_branch Lre5
Lok5:
    s_sub_u32 s44, s60, 20
    v_mov_b32 v3, s44
    s_waitcnt vmcnt(21)
    buffer_load_dwordx4 v6, s[28:31], s62 offen offset:0 sc1 nt lds
    s_waitcnt vmcnt(21)
    ds_write_b32 v16, v3 offset:0
    buffer_load_dwordx4 v7, s[28:31], s62 offen offset:1024 sc1 nt lds
    s_waitcnt vmcnt(21)
    buffer_load_dwordx4 v6, s[28:31], s62 offen offset:2048 sc1 nt lds
    s_waitcnt vmcnt(21)
    buffer_load_dwordx4 v7, s[28:31], s62 offen offset:3072 sc1 nt lds
    s_add_u32 s62, s62, 4096
    s_add_u32 s60, s60, 4
    s_lshl_b32 s44, s60, 10
    s_and_b32 m0, s44, 0x1ffff
    s_cmp_lt_u32 s60, s64
    s_cbranch_scc1 Lph4
    s_branch L_lvd
L_lv1:
    s_cmp_lg_u32 s65, 1
    s_cbranch_scc1 L_lv2
Lph6:
    s_add_u32 s44, s60, 4
Lre7:
    s_cmp_le_u32 s44, s61
    s_cbranch_scc1 Lok7
    ds_read_b128 v[8:11], v2 offset:16
    s_waitcnt lgkmcnt(0)
    v_min_u32 v8, v8, v9
    v_min3_u32 v8, v8, v10, v11
    s_nop 0
    v_readfirstlane_b32 s61, v8
    s_nop 1
    s_add_u32 s61, s61, 128
    s_add_u32 s47, s47, 1
    s_cmp_ge_u32 s47, 2000000
    s_cbranch_scc1 Lok7
    s_branch Lre7
Lok7:
    s_sub_u32 s44, s60, 16
    v_mov_b32 v3, s44
    s_waitcnt vmcnt(17)
    buffer_load_dwordx4 v6, s[28:31], s62 offen offset:0 sc1 nt lds
    s_waitcnt vmcnt(17)
    ds_write_b32 v16, v3 offset:0
    buffer_load_dwordx4 v7, s[28:31], s62 offen offset:1024 sc1 nt lds
    s_waitcnt vmcnt(17)
    buffer_load_dwordx4 v6, s[28:31], s62 offen offset:2048 sc1 nt lds
    s_waitcnt vmcnt(17)
    buffer_load_dwordx4 v7, s[28:31], s62 offen offset:3072 sc1 nt lds
    s_add_u32 s62, s62, 4096
    s_add_u32 s60, s60, 4
    s_lshl_b32 s44, s60, 10
    s_and_b32 m0, s44, 0x1ffff
    s_cmp_lt_u32 s60, s64
    s_cbranch_scc1 Lph6
    s_branch L_lvd
L_lv2:
    s_cmp_lg_u32 s65, 2
    s_cbranch_scc1 L_lv3
Lph8:
    s_add_u32 s44, s60, 4
Lre9:
    s_cmp_le_u32 s44, s61
    s_cbranch_scc1 Lok9
    ds_read_b128 v[8:11], v2 offset:16
    s_waitcnt lgkmcnt(0)
    v_min_u32 v8, v8, v9
    v_min3_u32 v8, v8, v10, v11
    s_nop 0
    v_readfirstlane_b32 s61, v8
    s_nop 1
    s_add_u32 s61, s61, 128
    s_add_u32 s47, s47, 1
    s_cmp_ge_u32 s47, 2000000
    s_cbranch_scc1 Lok9
    s_branch Lre9
Lok9:
    s_sub_u32 s44, s60, 16
    v_mov_b32 v3, s44
    s_waitcnt vmcnt(19)
    buffer_load_dwordx4 v6, s[28:31], s62 offen offset:0 sc1 nt lds
    s_waitcnt vmcnt(19)
    buffer_load_dwordx4 v7, s[28:31], s62 offen offset:1024 sc1 nt lds
    s_waitcnt vmcnt(19)
    buffer_load_dwordx4 v6, s[28:31], s62 offen offset:2048 sc1 nt lds
    s_waitcnt vmcnt(19)
    ds_write_b32 v16, v3 offset:0
    buffer_load_dwordx4 v7, s[28:31], s62 offen offset:3072 sc1 nt lds
    s_add_u32 s62, s62, 4096
    s_add_u32 s60, s60, 4
    s_lshl_b32 s44, s60, 10
    s_and_b32 m0, s44, 0x1ffff
    s_cmp_lt_u32 s60, s64
    s_cbranch_scc1 Lph8
    s_branch L_lvd
L_lv3:
    s_cmp_lg_u32 s65, 3
    s_cbranch_scc1 L_lv4
Lph10:
    s_add_u32 s44, s60, 4
Lre11:
    s_cmp_le_u32 s44, s61
    s_cbranch_scc1 Lok11
    ds_read_b128 v[8:11], v2 offset:16
    s_waitcnt lgkmcnt(0)
    v_min_u32 v8, v8, v9
    v_min3_u32 v8, v8, v10, v11
    s_nop 0
    v_readfirstlane_b32 s61, v8
    s_nop 1
    s_add_u32 s61, s61, 128
    s_add_u32 s47, s47, 1
    s_cmp_ge_u32 s47, 2000000
    s_cbranch_scc1 Lok11
    s_branch Lre11
Lok11:
    s_sub_u32 s44, s60, 24
    v_mov_b32 v3, s44
    s_waitcnt vmcnt(24)
    ds_write_b32 v16, v3 offset:0
    buffer_load_dwordx4 v6, s[28:31], s62 offen offset:0 sc1 nt lds
    s_waitcnt vmcnt(24)
    buffer_load_dwordx4 v7, s[28:31], s62 offen offset:1024 sc1 nt lds
    s_waitcnt vmcnt(24)
    buffer_load_dwordx4 v6, s[28:31], s62 offen offset:2048 sc1 nt lds
    s_waitcnt vmcnt(24)
    buffer_load_dwordx4 v7, s[28:31], s62 offen offset:3072 sc1 nt lds
    s_add_u32 s62, s62, 4096
    s_add_u32 s60, s60, 4
    s_lshl_b32 s44, s60, 10
    s_and_b32 m0, s44, 0x1ffff
    s_cmp_lt_u32 s60, s64
    s_cbranch_scc1 Lph10
    s_branch L_lvd
L_lv4:
Lph12:
    s_add_u32 s44, s60, 4
Lre13:
    s_cmp_le_u32 s44, s61
    s_cbranch_scc1 Lok13
    ds_read_b128 v[8:11], v2 offset:16
    s_waitcnt lgkmcnt(0)
    v_min_u32 v8, v8, v9
    v_min3_u32 v8, v8, v10, v11
    s_nop 0
    v_readfirstlane_b32 s61, v8
    s_nop 1
    s_add_u32 s61, s61, 128
    s_add_u32 s47, s47, 1
    s_cmp_ge_u32 s47, 2000000
    s_cbranch_scc1 Lok13
    s_branch Lre13
Lok13:
    s_sub_u32 s44, s60, 28
    v_mov_b32 v3, s44
    s_waitcnt vmcnt(29)
    buffer_load_dwordx4 v6, s[28:31], s62 offen offset:0 sc1 nt lds
    s_waitcnt vmcnt(29)
    ds_write_b32 v16, v3 offset:0
    buffer_load_dwordx4 v7, s[28:31], s62 offen offset:1024 sc1 nt lds
    s_waitcnt vmcnt(29)
    buffer_load_dwordx4 v6, s[28:31], s62 offen offset:2048 sc1 nt lds
    s_waitcnt vmcnt(29)
    buffer_load_dwordx4 v7, s[28:31], s62 offen offset:3072 sc1 nt lds
    s_add_u32 s62, s62, 4096
    s_add_u32 s60, s60, 4
    s_lshl_b32 s44, s60, 10
    s_and_b32 m0, s44, 0x1ffff
    s_cmp_lt_u32 s60, s64
    s_cbranch_scc1 Lph12
L_lvd:
    s_cmp_lt_u32 s60, s63
    s_cbranch_scc1 L_kv
    s_cmpk_eq_u32 s63, 608
    s_cbranch_scc1 L_kvdone
    s_mov_b64 s[28:29], s[8:9]
    s_lshl_b32 s62, s2, 18
    s_movk_i32 s63, 608
    s_branch L_kv
L_kvdone:
    s_mov_b64 s[32:33], s[20:21]
    s_mov_b32 s34, 7340032
    s_mov_b32 s35, 0x20000
    s_and_b32 s44, s59, 3
    s_lshl2_add_u32 s44, s58, s44
    s_mul_i32 s62, s44, 229376
    s_lshr_b32 s44, s59, 2
    s_lshl_b32 s44, s44, 8
    s_add_u32 s62, s62, s44
    v_mov_b32 v5, 0x40000000
Lph14:
    s_add_u32 s44, s60, 4
Lre15:
    s_cmp_le_u32 s44, s61
    s_cbranch_scc1 Lok15
    ds_read_b128 v[8:11], v2 offset:16
    s_waitcnt lgkmcnt(0)
    v_min_u32 v8, v8, v9
    v_min3_u32 v8, v8, v10, v11
    s_nop 0
    v_readfirstlane_b32 s61, v8
    s_nop 1
    s_add_u32 s61, s61, 128
    s_add_u32 s47, s47, 1
    s_cmp_ge_u32 s47, 2000000
    s_cbranch_scc1 Lok15
    s_branch Lre15
Lok15:
    s_sub_u32 s44, s60, 16
    v_mov_b32 v3, s44
    s_waitcnt vmcnt(19)
    buffer_load_dwordx4 v14, s[32:35], s62 offen offset:0 sc1 nt lds
    s_add_u32 s62, s62, 7168
    s_waitcnt vmcnt(19)
    buffer_load_dwordx4 v15, s[32:35], s62 offen offset:1024 sc1 nt lds
    s_add_u32 s62, s62, 7168
    s_waitcnt vmcnt(19)
    buffer_load_dwordx4 v14, s[32:35], s62 offen offset:2048 sc1 nt lds
    s_add_u32 s62, s62, 7168
    s_waitcnt vmcnt(19)
    ds_write_b32 v16, v3 offset:0
    buffer_load_dwordx4 v15, s[32:35], s62 offen offset:3072 sc1 nt lds
    s_add_u32 s62, s62, 11264
    s_add_u32 s60, s60, 4
    s_lshl_b32 s44, s60, 10
    s_and_b32 m0, s44, 0x1ffff
    s_cmp_lt_u32 s60, 636
    s_cbranch_scc1 Lph14
    s_add_u32 s44, s60, 4
Lre16:
    s_cmp_le_u32 s44, s61
    s_cbranch_scc1 Lok16
    ds_read_b128 v[8:11], v2 offset:16
    s_waitcnt lgkmcnt(0)
    v_min_u32 v8, v8, v9
    v_min3_u32 v8, v8, v10, v11
    s_nop 0
    v_readfirstlane_b32 s61, v8
    s_nop 1
    s_add_u32 s61, s61, 128
    s_add_u32 s47, s47, 1
    s_cmp_ge_u32 s47, 2000000
    s_cbranch_scc1 Lok16
    s_branch Lre16
Lok16:
    s_sub_u32 s44, s60, 16
    v_mov_b32 v3, s44
    s_waitcnt vmcnt(19)
    buffer_load_dwordx4 v5, s[32:35], s62 offen offset:0 sc1 nt lds
    s_waitcnt vmcnt(19)
    buffer_load_dwordx4 v5, s[32:35], s62 offen offset:1024 sc1 nt lds
    s_waitcnt vmcnt(19)
    buffer_load_dwordx4 v5, s[32:35], s62 offen offset:2048 sc1 nt lds
    s_waitcnt vmcnt(19)
    ds_write_b32 v16, v3 offset:0
    buffer_load_dwordx4 v5, s[32:35], s62 offen offset:3072 sc1 nt lds
    s_add_u32 s62, s62, 4096
    s_add_u32 s60, s60, 4
    s_lshl_b32 s44, s60, 10
    s_and_b32 m0, s44, 0x1ffff
    s_mov_b64 s[28:29], s[12:13]
    s_mov_b32 s30, 8388608
    s_mov_b32 s31, 0x20000
    s_lshr_b32 s62, s2, 6
    s_lshl_b32 s62, s62, 21
    s_and_b32 s44, s2, 8
    s_lshl_b32 s44, s44, 17
    s_add_u32 s62, s62, s44
    s_bfe_u32 s44, s2, 0x20004
    s_lshl_b32 s44, s44, 16
    s_add_u32 s62, s62, s44
    s_lshl_b32 s44, s58, 8
    s_add_u32 s62, s62, s44
Lph17:
    s_add_u32 s44, s60, 4
Lre18:
    s_cmp_le_u32 s44, s61
    s_cbranch_scc1 Lok18
    ds_read_b128 v[8:11], v2 offset:16
    s_waitcnt lgkmcnt(0)
    v_min_u32 v8, v8, v9
    v_min3_u32 v8, v8, v10, v11
    s_nop 0
    v_readfirstlane_b32 s61, v8
    s_nop 1
    s_add_u32 s61, s61, 128
    s_add_u32 s47, s47, 1
    s_cmp_ge_u32 s47, 2000000
    s_cbranch_scc1 Lok18
    s_branch Lre18
Lok18:
    s_sub_u32 s44, s60, 16
    v_mov_b32 v3, s44
    s_waitcnt vmcnt(19)
    buffer_load_dwordx4 v14, s[28:31], s62 offen offset:0 sc1 nt lds
    s_add_u32 s62, s62, 7168
    s_waitcnt vmcnt(19)
    buffer_load_dwordx4 v15, s[28:31], s62 offen offset:1024 sc1 nt lds
    s_add_u32 s62, s62, 7168
    s_waitcnt vmcnt(19)
    buffer_load_dwordx4 v14, s[28:31], s62 offen offset:2048 sc1 nt lds
    s_add_u32 s62, s62, 7168
    s_waitcnt vmcnt(19)
    ds_write_b32 v16, v3 offset:0
    buffer_load_dwordx4 v15, s[28:31], s62 offen offset:3072 sc1 nt lds
    s_add_u32 s62, s62, 11264
    s_add_u32 s60, s60, 4
    s_lshl_b32 s44, s60, 10
    s_and_b32 m0, s44, 0x1ffff
    s_bitcmp0_b32 s60, 2
    s_cselect_b32 s44, 196608, 0
    s_add_u32 s62, s62, s44
    s_cmp_lt_u32 s60, 672
    s_cbranch_scc1 Lph17
    v_mov_b32 v3, 656
    s_waitcnt vmcnt(16)
    ds_write_b32 v2, v3 offset:0
    v_mov_b32 v3, 664
    s_waitcnt vmcnt(8)
    ds_write_b32 v2, v3 offset:0
    v_mov_b32 v3, 672
    s_waitcnt vmcnt(0)
    ds_write_b32 v2, v3 offset:0
    s_endpgm
L_notloader:
    s_mov_b32 s48, 0xffff0000
    s_mov_b32 s49, 0x3fb8aa3b
    s_mul_i32 s50, s2, 8448
    s_mov_b32 s51, 0
    s_mov_b32 s53, 117835008
    s_mov_b32 s54, 117835009
    s_mov_b32 s55, 117835010
    s_mov_b32 s56, 117835011
    s_lshr_b32 s57, s2, 6
    s_getreg_b32 s74, hwreg(HW_REG_XCC_ID)
    s_lshl_b32 s74, s74, 28
    s_bitset1_b32 s74, 27
    s_waitcnt lgkmcnt(0)
    s_add_u32 s60, s26, 3145728
    s_addc_u32 s61, s27, 0
    s_load_dword s46, s[60:61], 0
    s_mov_b64 s[36:37], s[26:27]
    s_mov_b32 s38, 268435456
    s_mov_b32 s39, 0x20000
    s_cmp_lg_u32 s3, 6
    s_cbranch_scc1 L_notpacer
    s_lshl_b32 s62, s58, 8
    s_add_u32 s62, s62, 3149824
    s_lshl2_add_u32 s63, s59, s62
    v_lshlrev_b32 v4, 2, v1
    s_waitcnt lgkmcnt(0)
    s_barrier
    s_add_u32 s46, s46, 1
    s_lshr_b32 s44, s74, 12
    s_xor_b32 s64, s46, s44
    s_and_b32 s64, s64, 0xfffff
    s_and_b32 s67, s46, 0xfffff
    v_lshlrev_b32 v8, 8, v1
    s_add_u32 s68, s62, 2048
    s_mov_b32 s69, 3151872
Lre19:
    s_cmp_ge_i32 s51, 96
    s_cbranch_scc1 Lok19
    ds_read_b32 v3, v2 offset:0
    s_waitcnt lgkmcnt(0)
    v_readfirstlane_b32 s51, v3
    s_nop 1
    s_cmp_ge_i32 s51, 96
    s_cbranch_scc1 Lok19
    s_add_u32 s47, s47, 1
    s_cmp_ge_u32 s47, 2000000
    s_cbranch_scc1 Lok19
    s_sleep 8
    s_branch Lre19
Lok19:
    s_mov_b32 exec_hi, 1
L_pace:
    ds_read_b32 v3, v2 offset:0
    s_waitcnt lgkmcnt(0)
    v_lshlrev_b32 v5, 20, v3
    v_or_b32 v5, s64, v5
    v_readfirstlane_b32 s51, v3
    s_mov_b64 exec, 1
    buffer_store_dword v5, off, s[36:39], s63
    s_mov_b32 exec_lo, -1
    s_mov_b32 exec_hi, 1
    s_sleep 6
    buffer_load_dword v6, v4, s[36:39], s62 offen sc1
    s_waitcnt vmcnt(0)
    v_and_b32 v7, 0xfffff, v6
    v_ashrrev_i32 v6, 20, v6
    v_cmp_eq_u32 vcc, s64, v7
    s_nop 1
    v_cndmask_b32 v9, 0, v6, vcc
    v_sub_u32 v6, v6, v3
    v_cndmask_b32 v6, 0, v6, vcc
    s_nop 1
    v_add_u32_dpp v6, v6, v6 row_ror:1 row_mask:0xf bank_mask:0xf
    s_nop 1
    v_add_u32_dpp v6, v6, v6 row_ror:2 row_mask:0xf bank_mask:0xf
    s_nop 1
    v_add_u32_dpp v6, v6, v6 row_ror:4 row_mask:0xf bank_mask:0xf
    s_nop 1
    v_add_u32_dpp v6, v6, v6 row_ror:8 row_mask:0xf bank_mask:0xf
    s_nop 0
    v_readlane_b32 s65, v6, 0
    v_readlane_b32 s66, v6, 16
    s_nop 1
    s_add_u32 s65, s65, s66
    s_ashr_i32 s65, s65, 5
    s_mov_b32 s66, 1
    s_cmp_ge_i32 s65, -16
    s_cselect_b32 s66, 2, s66
    s_cmp_ge_i32 s65, -6
    s_cselect_b32 s66, 0, s66
    s_cmp_ge_i32 s65, 8
    s_cselect_b32 s66, 3, s66
    s_cmp_ge_i32 s65, 20
    s_cselect_b32 s66, 4, s66
    v_mov_b32 v3, s66
    ds_write_b32 v2, v3 offset:12
    s_add_u32 s47, s47, 1
    s_cmp_ge_u32 s47, 100000
    s_cbranch_scc1 L_paced
    s_cmpk_lt_u32 s51, 576
    s_cbranch_scc1 L_pace
L_paced:
    v_mov_b32 v5, 637534208
    v_or_b32 v5, s64, v5
    s_mov_b64 exec, 1
    buffer_store_dword v5, off, s[36:39], s63
    s_endpgm
L_notpacer:
    s_cmp_lg_u32 s3, 1
    s_cbranch_scc1 L_consumer
    s_mov_b64 s[40:41], s[4:5]
    s_mov_b32 s42, 2048
    s_mov_b32 s43, 0x20000
    v_lshlrev_b32 v6, 5, v1
    buffer_load_dwordx4 v[16:19], v6, s[40:43], 0 offen
    buffer_load_dwordx4 v[20:23], v6, s[40:43], 0 offen offset:16
    v_mov_b32 v8, 0
    v_mov_b32 v9, 0
    v_mov_b32 v10, 0
    v_mov_b32 v11, 0
    ds_write_b128 v2, v[8:11] offset:0
    ds_write_b128 v2, v[8:11] offset:16
    ds_write_b128 v2, v[8:11] offset:32
    ds_write_b128 v2, v[8:11] offset:48
    s_waitcnt lgkmcnt(0)
    s_barrier
    s_add_u32 s46, s46, 1
    s_bfe_u32 s70, s46, 524288
    s_bfe_u32 s71, s46, 524296
    s_bfe_u32 s72, s46, 524304
    s_bfe_u32 s73, s46, 524312
    s_waitcnt vmcnt(0)
    v_lshlrev_b32 v24, 16, v16
    v_and_b32 v25, s48, v16
    v_lshlrev_b32 v26, 16, v17
    v_and_b32 v27, s48, v17
    v_lshlrev_b32 v28, 16, v18
    v_and_b32 v29, s48, v18
    v_lshlrev_b32 v30, 16, v19
    v_and_b32 v31, s48, v19
    v_lshlrev_b32 v32, 16, v20
    v_and_b32 v33, s48, v20
    v_lshlrev_b32 v34, 16, v21
    v_and_b32 v35, s48, v21
    v_lshlrev_b32 v36, 16, v22
    v_and_b32 v37, s48, v22
    v_lshlrev_b32 v38, 16, v23
    v_and_b32 v39, s48, v23
    v_add_f32 v8, v24, v25
    v_add_f32 v9, v26, v27
    v_add_f32 v8, v8, v28
    v_add_f32 v9, v9, v29
    v_add_f32 v8, v8, v30
    v_add_f32 v9, v9, v31
    v_add_f32 v8, v8, v32
    v_add_f32 v9, v9, v33
    v_add_f32 v8, v8, v34
    v_add_f32 v9, v9, v35
    v_add_f32 v8, v8, v36
    v_add_f32 v9, v9, v37
    v_add_f32 v8, v8, v38
    v_add_f32 v9, v9, v39
    v_add_f32 v8, v8, v9
    s_nop 1
    v_add_f32_dpp v8, v8, v8 row_ror:1 row_mask:0xf bank_mask:0xf
    s_nop 1
    v_add_f32_dpp v8, v8, v8 row_ror:2 row_mask:0xf bank_mask:0xf
    s_nop 1
    v_add_f32_dpp v8, v8, v8 row_ror:4 row_mask:0xf bank_mask:0xf
    s_nop 1
    v_add_f32_dpp v8, v8, v8 row_ror:8 row_mask:0xf bank_mask:0xf
    v_mov_b32 v9, v8
    s_nop 1
    v_permlane16_swap_b32 v8, v9
    v_add_f32 v8, v8, v9
    v_mov_b32 v9, v8
    s_nop 1
    v_permlane32_swap_b32 v8, v9
    v_add_f32 v8, v8, v9
    v_mul_f32 v8, 0x3a800000, v8
    v_sub_f32 v11, v24, v8
    v_mul_f32 v10, v11, v11
    v_sub_f32 v11, v25, v8
    v_fmac_f32 v10, v11, v11
    v_sub_f32 v11, v26, v8
    v_fmac_f32 v10, v11, v11
    v_sub_f32 v11, v27, v8
    v_fmac_f32 v10, v11, v11
    v_sub_f32 v11, v28, v8
    v_fmac_f32 v10, v11, v11
    v_sub_f32 v11, v29, v8
    v_fmac_f32 v10, v11, v11
    v_sub_f32 v11, v30, v8
    v_fmac_f32 v10, v11, v11
    v_sub_f32 v11, v31, v8
    v_fmac_f32 v10, v11, v11
    v_sub_f32 v11, v32, v8
    v_fmac_f32 v10, v11, v11
    v_sub_f32 v11, v33, v8
    v_fmac_f32 v10, v11, v11
    v_sub_f32 v11, v34, v8
    v_fmac_f32 v10, v11, v11
    v_sub_f32 v11, v35, v8
    v_fmac_f32 v10, v11, v11
    v_sub_f32 v11, v36, v8
    v_fmac_f32 v10, v11, v11
    v_sub_f32 v11, v37, v8
    v_fmac_f32 v10, v11, v11
    v_sub_f32 v11, v38, v8
    v_fmac_f32 v10, v11, v11
    v_sub_f32 v11, v39, v8
    v_fmac_f32 v10, v11, v11
    s_nop 1
    v_add_f32_dpp v10, v10, v10 row_ror:1 row_mask:0xf bank_mask:0xf
    s_nop 1
    v_add_f32_dpp v10, v10, v10 row_ror:2 row_mask:0xf bank_mask:0xf
    s_nop 1
    v_add_f32_dpp v10, v10, v10 row_ror:4 row_mask:0xf bank_mask:0xf
    s_nop 1
    v_add_f32_dpp v10, v10, v10 row_ror:8 row_mask:0xf bank_mask:0xf
    v_mov_b32 v9, v10
    s_nop 1
    v_permlane16_swap_b32 v10, v9
    v_add_f32 v10, v10, v9
    v_mov_b32 v9, v10
    s_nop 1
    v_permlane32_swap_b32 v10, v9
    v_add_f32 v10, v10, v9
    v_mul_f32 v10, 0x3a800000, v10
    v_cvt_pk_bf16_f32 v9, v8, v10
    v_lshlrev_b32 v8, 16, v9
    v_and_b32 v10, s48, v9
    v_add_f32 v10, 0x3727c5ac, v10
    v_cvt_pk_bf16_f32 v10, v10, v10
    v_lshlrev_b32 v10, 16, v10
    v_sqrt_f32 v10, v10
    s_nop 0
    v_cvt_pk_bf16_f32 v10, v10, v10
    v_lshlrev_b32 v10, 16, v10
    v_rcp_f32 v10, v10
    v_sub_f32 v24, v24, v8
    v_sub_f32 v25, v25, v8
    v_cvt_pk_bf16_f32 v9, v24, v25
    v_lshlrev_b32 v24, 16, v9
    v_and_b32 v25, s48, v9
    v_mul_f32 v24, v24, v10
    v_mul_f32 v25, v25, v10
    v_cvt_pk_bf16_f32 v16, v24, v25
    v_sub_f32 v26, v26, v8
    v_sub_f32 v27, v27, v8
    v_cvt_pk_bf16_f32 v9, v26, v27
    v_lshlrev_b32 v26, 16, v9
    v_and_b32 v27, s48, v9
    v_mul_f32 v26, v26, v10
    v_mul_f32 v27, v27, v10
    v_cvt_pk_bf16_f32 v17, v26, v27
    v_sub_f32 v28, v28, v8
    v_sub_f32 v29, v29, v8
    v_cvt_pk_bf16_f32 v9, v28, v29
    v_lshlrev_b32 v28, 16, v9
    v_and_b32 v29, s48, v9
    v_mul_f32 v28, v28, v10
    v_mul_f32 v29, v29, v10
    v_cvt_pk_bf16_f32 v18, v28, v29
    v_sub_f32 v30, v30, v8
    v_sub_f32 v31, v31, v8
    v_cvt_pk_bf16_f32 v9, v30, v31
    v_lshlrev_b32 v30, 16, v9
    v_and_b32 v31, s48, v9
    v_mul_f32 v30, v30, v10
    v_mul_f32 v31, v31, v10
    v_cvt_pk_bf16_f32 v19, v30, v31
    v_sub_f32 v32, v32, v8
    v_sub_f32 v33, v33, v8
    v_cvt_pk_bf16_f32 v9, v32, v33
    v_lshlrev_b32 v32, 16, v9
    v_and_b32 v33, s48, v9
    v_mul_f32 v32, v32, v10
    v_mul_f32 v33, v33, v10
    v_cvt_pk_bf16_f32 v20, v32, v33
    v_sub_f32 v34, v34, v8
    v_sub_f32 v35, v35, v8
    v_cvt_pk_bf16_f32 v9, v34, v35
    v_lshlrev_b32 v34, 16, v9
    v_and_b32 v35, s48, v9
    v_mul_f32 v34, v34, v10
    v_mul_f32 v35, v35, v10
    v_cvt_pk_bf16_f32 v21, v34, v35
    v_sub_f32 v36, v36, v8
    v_sub_f32 v37, v37, v8
    v_cvt_pk_bf16_f32 v9, v36, v37
    v_lshlrev_b32 v36, 16, v9
    v_and_b32 v37, s48, v9
    v_mul_f32 v36, v36, v10
    v_mul_f32 v37, v37, v10
    v_cvt_pk_bf16_f32 v22, v36, v37
    v_sub_f32 v38, v38, v8
    v_sub_f32 v39, v39, v8
    v_cvt_pk_bf16_f32 v9, v38, v39
    v_lshlrev_b32 v38, 16, v9
    v_and_b32 v39, s48, v9
    v_mul_f32 v38, v38, v10
    v_mul_f32 v39, v39, v10
    v_cvt_pk_bf16_f32 v23, v38, v39
    v_add_u32 v6, v2, v6
    ds_write_b128 v6, v[16:19] offset:256
    ds_write_b128 v6, v[20:23] offset:272
    v_mov_b32 v3, 1
    s_mov_b64 exec, 1
    ds_add_u32 v2, v3 offset:32
    s_mov_b64 exec, -1
    v_lshlrev_b32 v14, 4, v1
    v_mov_b32 v8, -1
    v_mov_b32 v9, -1
    v_mov_b32 v10, -1
    v_mov_b32 v11, -1
    buffer_store_dwordx4 v[8:11], v14, s[36:39], s50 offen sc1
    buffer_store_dwordx4 v[8:11], v14, s[36:39], s50 offen offset:1024 sc1
    v_and_b32 v4, 1, v1
    v_lshrrev_b32 v5, 5, v1
    v_lshl_add_u32 v4, v5, 4, v4
    v_lshlrev_b32 v13, 1, v4
    s_lshl_b32 s64, s58, 8
    s_lshl_b32 s44, s57, 6
    s_add_u32 s64, s64, s44
    s_and_b32 s44, s59, 7
    s_lshl2_add_u32 s64, s44, s64
    buffer_load_ushort v12, v13, s[40:43], s64 offen
    s_mov_b64 s[32:33], s[22:23]
    s_mov_b32 s34, 2048
    s_mov_b32 s35, 0x20000
    s_mov_b64 exec, 1
    s_lshl_b32 s44, s2, 18
    s_lshl_b32 s45, s57, 21
    s_mul_i32 s65, s58, 917504
    s_mov_b64 s[28:29], s[6:7]
    s_mov_b32 s30, 67108864
    s_mov_b32 s31, 0x20000
    buffer_load_dword v160, off, s[28:31], s44
    s_mov_b64 s[28:29], s[8:9]
    s_mov_b32 s30, 67108864
    s_mov_b32 s31, 0x20000
    buffer_load_dword v160, off, s[28:31], s44
    s_mov_b64 s[28:29], s[12:13]
    s_mov_b32 s30, 8388608
    s_mov_b32 s31, 0x20000
    buffer_load_dword v160, off, s[28:31], s45
    s_mov_b64 s[28:29], s[20:21]
    s_mov_b32 s30, 7340032
    s_mov_b32 s31, 0x20000
    buffer_load_dword v160, off, s[28:31], s65
    buffer_load_dword v160, off, s[32:35], 0
    s_mov_b64 exec, -1
    v_bfe_u32 v8, v1, 4, 1
    v_lshrrev_b32 v9, 5, v1
    v_lshl_add_u32 v8, v8, 2, v9
    v_mul_u32_u24 v8, 8448, v8
    v_and_b32 v9, 15, v1
    v_lshl_add_u32 v15, v9, 4, v8
    s_mul_i32 s65, s57, 540672
    s_add_u32 s65, s65, 7680
Lre20:
    s_cmp_ge_i32 s51, 120
    s_cbranch_scc1 Lok20
    ds_read_b32 v3, v2 offset:0
    s_waitcnt lgkmcnt(0)
    v_readfirstlane_b32 s51, v3
    s_nop 1
    s_cmp_ge_i32 s51, 120
    s_cbranch_scc1 Lok20
    s_add_u32 s47, s47, 1
    s_cmp_ge_u32 s47, 2000000
    s_cbranch_scc1 Lok20
    s_sleep 4
    s_branch Lre20
Lok20:
Lre21:
    s_mov_b32 s45, s65
    buffer_load_dwordx4 v[32:35], v15, s[36:39], s45 offen sc1
    s_add_u32 s45, s45, 16896
    buffer_load_dwordx4 v[64:67], v15, s[36:39], s45 offen sc1
    s_add_u32 s45, s45, 50688
    buffer_load_dwordx4 v[36:39], v15, s[36:39], s45 offen sc1
    s_add_u32 s45, s45, 16896
    buffer_load_dwordx4 v[68:71], v15, s[36:39], s45 offen sc1
    s_add_u32 s45, s45, 50688
    buffer_load_dwordx4 v[40:43], v15, s[36:39], s45 offen sc1
    s_add_u32 s45, s45, 16896
    buffer_load_dwordx4 v[72:75], v15, s[36:39], s45 offen sc1
    s_add_u32 s45, s45, 50688
    buffer_load_dwordx4 v[44:47], v15, s[36:39], s45 offen sc1
    s_add_u32 s45, s45, 16896
    buffer_load_dwordx4 v[76:79], v15, s[36:39], s45 offen sc1
    s_add_u32 s45, s45, 50688
    buffer_load_dwordx4 v[48:51], v15, s[36:39], s45 offen sc1
    s_add_u32 s45, s45, 16896
    buffer_load_dwordx4 v[80:83], v15, s[36:39], s45 offen sc1
    s_add_u32 s45, s45, 50688
    buffer_load_dwordx4 v[52:55], v15, s[36:39], s45 offen sc1
    s_add_u32 s45, s45, 16896
    buffer_load_dwordx4 v[84:87], v15, s[36:39], s45 offen sc1
    s_add_u32 s45, s45, 50688
    buffer_load_dwordx4 v[56:59], v15, s[36:39], s45 offen sc1
    s_add_u32 s45, s45, 16896
    buffer_load_dwordx4 v[88:91], v15, s[36:39], s45 offen sc1
    s_add_u32 s45, s45, 50688
    buffer_load_dwordx4 v[60:63], v15, s[36:39], s45 offen sc1
    s_add_u32 s45, s45, 16896
    buffer_load_dwordx4 v[92:95], v15, s[36:39], s45 offen sc1
    s_add_u32 s45, s45, 50688
    s_waitcnt vmcnt(0)
Lck21:
    v_xor_b32 v32, s70, v32
    v_xor_b32 v33, s71, v33
    v_xor_b32 v34, s72, v34
    v_xor_b32 v35, s73, v35
    v_xor_b32 v36, s70, v36
    v_xor_b32 v37, s71, v37
    v_xor_b32 v38, s72, v38
    v_xor_b32 v39, s73, v39
    v_xor_b32 v40, s70, v40
    v_xor_b32 v41, s71, v41
    v_xor_b32 v42, s72, v42
    v_xor_b32 v43, s73, v43
    v_xor_b32 v44, s70, v44
    v_xor_b32 v45, s71, v45
    v_xor_b32 v46, s72, v46
    v_xor_b32 v47, s73, v47
    v_xor_b32 v48, s70, v48
    v_xor_b32 v49, s71, v49
    v_xor_b32 v50, s72, v50
    v_xor_b32 v51, s73, v51
    v_xor_b32 v52, s70, v52
    v_xor_b32 v53, s71, v53
    v_xor_b32 v54, s72, v54
    v_xor_b32 v55, s73, v55
    v_xor_b32 v56, s70, v56
    v_xor_b32 v57, s71, v57
    v_xor_b32 v58, s72, v58
    v_xor_b32 v59, s73, v59
    v_xor_b32 v60, s70, v60
    v_xor_b32 v61, s71, v61
    v_xor_b32 v62, s72, v62
    v_xor_b32 v63, s73, v63
    v_xor_b32 v64, s70, v64
    v_xor_b32 v65, s71, v65
    v_xor_b32 v66, s72, v66
    v_xor_b32 v67, s73, v67
    v_xor_b32 v68, s70, v68
    v_xor_b32 v69, s71, v69
    v_xor_b32 v70, s72, v70
    v_xor_b32 v71, s73, v71
    v_xor_b32 v72, s70, v72
    v_xor_b32 v73, s71, v73
    v_xor_b32 v74, s72, v74
    v_xor_b32 v75, s73, v75
    v_xor_b32 v76, s70, v76
    v_xor_b32 v77, s71, v77
    v_xor_b32 v78, s72, v78
    v_xor_b32 v79, s73, v79
    v_xor_b32 v80, s70, v80
    v_xor_b32 v81, s71, v81
    v_xor_b32 v82, s72, v82
    v_xor_b32 v83, s73, v83
    v_xor_b32 v84, s70, v84
    v_xor_b32 v85, s71, v85
    v_xor_b32 v86, s72, v86
    v_xor_b32 v87, s73, v87
    v_xor_b32 v88, s70, v88
    v_xor_b32 v89, s71, v89
    v_xor_b32 v90, s72, v90
    v_xor_b32 v91, s73, v91
    v_xor_b32 v92, s70, v92
    v_xor_b32 v93, s71, v93
    v_xor_b32 v94, s72, v94
    v_xor_b32 v95, s73, v95
    v_or_b32 v3, v32, v33
    v_or3_b32 v3, v3, v34, v35
    v_or3_b32 v3, v3, v36, v37
    v_or3_b32 v3, v3, v38, v39
    v_or3_b32 v3, v3, v40, v41
    v_or3_b32 v3, v3, v42, v43
    v_or3_b32 v3, v3, v44, v45
    v_or3_b32 v3, v3, v46, v47
    v_or3_b32 v3, v3, v48, v49
    v_or3_b32 v3, v3, v50, v51
    v_or3_b32 v3, v3, v52, v53
    v_or3_b32 v3, v3, v54, v55
    v_or3_b32 v3, v3, v56, v57
    v_or3_b32 v3, v3, v58, v59
    v_or3_b32 v3, v3, v60, v61
    v_or3_b32 v3, v3, v62, v63
    v_or3_b32 v3, v3, v64, v65
    v_or3_b32 v3, v3, v66, v67
    v_or3_b32 v3, v3, v68, v69
    v_or3_b32 v3, v3, v70, v71
    v_or3_b32 v3, v3, v72, v73
    v_or3_b32 v3, v3, v74, v75
    v_or3_b32 v3, v3, v76, v77
    v_or3_b32 v3, v3, v78, v79
    v_or3_b32 v3, v3, v80, v81
    v_or3_b32 v3, v3, v82, v83
    v_or3_b32 v3, v3, v84, v85
    v_or3_b32 v3, v3, v86, v87
    v_or3_b32 v3, v3, v88, v89
    v_or3_b32 v3, v3, v90, v91
    v_or3_b32 v3, v3, v92, v93
    v_or3_b32 v3, v3, v94, v95
    v_and_b32 v3, 0xff, v3
    v_cmp_ne_u32 vcc, 0, v3
    s_nop 4
    s_cbranch_vccz Lok21
    s_add_u32 s47, s47, 1
    s_cmp_ge_u32 s47, 2000000
    s_cbranch_scc1 Lok21
    s_sleep 8
    s_mov_b64 exec, vcc
    s_branch Lre21
Lok21:
    s_mov_b64 exec, -1
    v_and_b32 v9, 31, v1
    v_lshlrev_b32 v9, 3, v9
    v_lshrrev_b32 v8, 5, v1
    v_mul_u32_u24 v8, 272, v8
    v_add3_u32 v9, v9, v8, v2
    v_add_f32 v32, v32, v64
    v_add_f32 v33, v33, v65
    v_add_f32 v34, v34, v66
    v_add_f32 v35, v35, v67
    v_add_f32 v36, v36, v68
    v_add_f32 v37, v37, v69
    v_add_f32 v38, v38, v70
    v_add_f32 v39, v39, v71
    v_add_f32 v40, v40, v72
    v_add_f32 v41, v41, v73
    v_add_f32 v42, v42, v74
    v_add_f32 v43, v43, v75
    v_add_f32 v44, v44, v76
    v_add_f32 v45, v45, v77
    v_add_f32 v46, v46, v78
    v_add_f32 v47, v47, v79
    v_add_f32 v48, v48, v80
    v_add_f32 v49, v49, v81
    v_add_f32 v50, v50, v82
    v_add_f32 v51, v51, v83
    v_add_f32 v52, v52, v84
    v_add_f32 v53, v53, v85
    v_add_f32 v54, v54, v86
    v_add_f32 v55, v55, v87
    v_add_f32 v56, v56, v88
    v_add_f32 v57, v57, v89
    v_add_f32 v58, v58, v90
    v_add_f32 v59, v59, v91
    v_add_f32 v60, v60, v92
    v_add_f32 v61, v61, v93
    v_add_f32 v62, v62, v94
    v_add_f32 v63, v63, v95
    v_permlane32_swap_b32 v32, v36
    v_permlane32_swap_b32 v33, v37
    v_permlane32_swap_b32 v34, v38
    v_permlane32_swap_b32 v35, v39
    v_add_f32 v32, v32, v36
    v_add_f32 v33, v33, v37
    v_add_f32 v34, v34, v38
    v_add_f32 v35, v35, v39
    v_cvt_pk_bf16_f32 v32, v32, v33
    v_cvt_pk_bf16_f32 v33, v34, v35
    ds_write_b64 v9, v[32:33] offset:2304
    v_permlane32_swap_b32 v40, v44
    v_permlane32_swap_b32 v41, v45
    v_permlane32_swap_b32 v42, v46
    v_permlane32_swap_b32 v43, v47
    v_add_f32 v40, v40, v44
    v_add_f32 v41, v41, v45
    v_add_f32 v42, v42, v46
    v_add_f32 v43, v43, v47
    v_cvt_pk_bf16_f32 v40, v40, v41
    v_cvt_pk_bf16_f32 v41, v42, v43
    ds_write_b64 v9, v[40:41] offset:2848
    v_permlane32_swap_b32 v48, v52
    v_permlane32_swap_b32 v49, v53
    v_permlane32_swap_b32 v50, v54
    v_permlane32_swap_b32 v51, v55
    v_add_f32 v48, v48, v52
    v_add_f32 v49, v49, v53
    v_add_f32 v50, v50, v54
    v_add_f32 v51, v51, v55
    v_cvt_pk_bf16_f32 v48, v48, v49
    v_cvt_pk_bf16_f32 v49, v50, v51
    ds_write_b64 v9, v[48:49] offset:3392
    v_permlane32_swap_b32 v56, v60
    v_permlane32_swap_b32 v57, v61
    v_permlane32_swap_b32 v58, v62
    v_permlane32_swap_b32 v59, v63
    v_add_f32 v56, v56, v60
    v_add_f32 v57, v57, v61
    v_add_f32 v58, v58, v62
    v_add_f32 v59, v59, v63
    v_cvt_pk_bf16_f32 v56, v56, v57
    v_cvt_pk_bf16_f32 v57, v58, v59
    ds_write_b64 v9, v[56:57] offset:3936
    v_mov_b32 v3, 1
    s_mov_b64 exec, 1
    ds_add_u32 v2, v3 offset:36
    s_mov_b64 exec, -1
    v_lshrrev_b32 v8, 5, v1
    v_mul_u32_u24 v8, 67584, v8
    v_and_b32 v9, 31, v1
    v_lshl_add_u32 v15, v9, 4, v8
    s_mul_i32 s65, s58, 8448
    s_and_b32 s44, s59, 3
    s_mul_i32 s44, s44, 448
    s_add_u32 s65, s65, s44
    s_add_u32 s65, s65, 4096
    s_lshr_b32 s67, s74, 24
    s_xor_b32 s73, s73, s67
    s_mov_b32 s66, 0
    s_movk_i32 s68, 1792
    v_mov_b32 v32, 0
    v_mov_b32 v33, 0
    v_mov_b32 v34, 0
    v_mov_b32 v35, 0
    v_mov_b32 v36, 0
    v_mov_b32 v37, 0
    v_mov_b32 v38, 0
    v_mov_b32 v39, 0
    v_mov_b32 v40, 0
    v_mov_b32 v41, 0
    v_mov_b32 v42, 0
    v_mov_b32 v43, 0
    v_mov_b32 v44, 0
    v_mov_b32 v45, 0
    v_mov_b32 v46, 0
    v_mov_b32 v47, 0
    v_mov_b32 v48, 0
    v_mov_b32 v49, 0
    v_mov_b32 v50, 0
    v_mov_b32 v51, 0
    v_mov_b32 v52, 0
    v_mov_b32 v53, 0
    v_mov_b32 v54, 0
    v_mov_b32 v55, 0
    v_mov_b32 v56, 0
    v_mov_b32 v57, 0
    v_mov_b32 v58, 0
    v_mov_b32 v59, 0
    v_mov_b32 v60, 0
    v_mov_b32 v61, 0
    v_mov_b32 v62, 0
    v_mov_b32 v63, 0
    v_mov_b32 v64, 0
    v_mov_b32 v65, 0
    v_mov_b32 v66, 0
    v_mov_b32 v67, 0
    v_mov_b32 v68, 0
    v_mov_b32 v69, 0
    v_mov_b32 v70, 0
    v_mov_b32 v71, 0
    v_mov_b32 v72, 0
    v_mov_b32 v73, 0
    v_mov_b32 v74, 0
    v_mov_b32 v75, 0
    v_mov_b32 v76, 0
    v_mov_b32 v77, 0
    v_mov_b32 v78, 0
    v_mov_b32 v79, 0
    v_mov_b32 v80, 0
    v_mov_b32 v81, 0
    v_mov_b32 v82, 0
    v_mov_b32 v83, 0
    v_mov_b32 v84, 0
    v_mov_b32 v85, 0
    v_mov_b32 v86, 0
    v_mov_b32 v87, 0
    v_mov_b32 v88, 0
    v_mov_b32 v89, 0
    v_mov_b32 v90, 0
    v_mov_b32 v91, 0
    v_mov_b32 v92, 0
    v_mov_b32 v93, 0
    v_mov_b32 v94, 0
    v_mov_b32 v95, 0
Lre22:
    s_cmp_ge_i32 s51, 296
    s_cbranch_scc1 Lok22
    ds_read_b32 v3, v2 offset:0
    s_waitcnt lgkmcnt(0)
    v_readfirstlane_b32 s51, v3
    s_nop 1
    s_cmp_ge_i32 s51, 296
    s_cbranch_scc1 Lok22
    s_add_u32 s47, s47, 1
    s_cmp_ge_u32 s47, 2000000
    s_cbranch_scc1 Lok22
    s_sleep 8
    s_branch Lre22
Lok22:
    s_mov_b32 exec_lo, 0x0fffffff
    s_mov_b32 exec_hi, 0x0fffffff
Lre23:
    s_mov_b32 s45, s65
    buffer_load_dwordx4 v[32:35], v15, s[36:39], s45 offen sc1
    s_add_u32 s45, s45, 135168
    buffer_load_dwordx4 v[36:39], v15, s[36:39], s45 offen sc1
    s_add_u32 s45, s45, 135168
    buffer_load_dwordx4 v[40:43], v15, s[36:39], s45 offen sc1
    s_add_u32 s45, s45, 135168
    buffer_load_dwordx4 v[44:47], v15, s[36:39], s45 offen sc1
    s_add_u32 s45, s45, 135168
    buffer_load_dwordx4 v[48:51], v15, s[36:39], s45 offen sc1
    s_add_u32 s45, s45, 135168
    buffer_load_dwordx4 v[52:55], v15, s[36:39], s45 offen sc1
    s_add_u32 s45, s45, 135168
    buffer_load_dwordx4 v[56:59], v15, s[36:39], s45 offen sc1
    s_add_u32 s45, s45, 135168
    buffer_load_dwordx4 v[60:63], v15, s[36:39], s45 offen sc1
    s_add_u32 s45, s45, 135168
    buffer_load_dwordx4 v[64:67], v15, s[36:39], s45 offen sc1
    s_add_u32 s45, s45, 135168
    buffer_load_dwordx4 v[68:71], v15, s[36:39], s45 offen sc1
    s_add_u32 s45, s45, 135168
    buffer_load_dwordx4 v[72:75], v15, s[36:39], s45 offen sc1
    s_add_u32 s45, s45, 135168
    buffer_load_dwordx4 v[76:79], v15, s[36:39], s45 offen sc1
    s_add_u32 s45, s45, 135168
    buffer_load_dwordx4 v[80:83], v15, s[36:39], s45 offen sc1
    s_add_u32 s45, s45, 135168
    buffer_load_dwordx4 v[84:87], v15, s[36:39], s45 offen sc1
    s_add_u32 s45, s45, 135168
    buffer_load_dwordx4 v[88:91], v15, s[36:39], s45 offen sc1
    s_add_u32 s45, s45, 135168
    buffer_load_dwordx4 v[92:95], v15, s[36:39], s45 offen sc1
    s_add_u32 s45, s45, 135168
    s_waitcnt vmcnt(0)
Lck23:
    v_xor_b32 v32, s70, v32
    v_xor_b32 v33, s71, v33
    v_xor_b32 v34, s72, v34
    v_xor_b32 v35, s73, v35
    v_xor_b32 v36, s70, v36
    v_xor_b32 v37, s71, v37
    v_xor_b32 v38, s72, v38
    v_xor_b32 v39, s73, v39
    v_xor_b32 v40, s70, v40
    v_xor_b32 v41, s71, v41
    v_xor_b32 v42, s72, v42
    v_xor_b32 v43, s73, v43
    v_xor_b32 v44, s70, v44
    v_xor_b32 v45, s71, v45
    v_xor_b32 v46, s72, v46
    v_xor_b32 v47, s73, v47
    v_xor_b32 v48, s70, v48
    v_xor_b32 v49, s71, v49
    v_xor_b32 v50, s72, v50
    v_xor_b32 v51, s73, v51
    v_xor_b32 v52, s70, v52
    v_xor_b32 v53, s71, v53
    v_xor_b32 v54, s72, v54
    v_xor_b32 v55, s73, v55
    v_xor_b32 v56, s70, v56
    v_xor_b32 v57, s71, v57
    v_xor_b32 v58, s72, v58
    v_xor_b32 v59, s73, v59
    v_xor_b32 v60, s70, v60
    v_xor_b32 v61, s71, v61
    v_xor_b32 v62, s72, v62
    v_xor_b32 v63, s73, v63
    v_xor_b32 v64, s70, v64
    v_xor_b32 v65, s71, v65
    v_xor_b32 v66, s72, v66
    v_xor_b32 v67, s73, v67
    v_xor_b32 v68, s70, v68
    v_xor_b32 v69, s71, v69
    v_xor_b32 v70, s72, v70
    v_xor_b32 v71, s73, v71
    v_xor_b32 v72, s70, v72
    v_xor_b32 v73, s71, v73
    v_xor_b32 v74, s72, v74
    v_xor_b32 v75, s73, v75
    v_xor_b32 v76, s70, v76
    v_xor_b32 v77, s71, v77
    v_xor_b32 v78, s72, v78
    v_xor_b32 v79, s73, v79
    v_xor_b32 v80, s70, v80
    v_xor_b32 v81, s71, v81
    v_xor_b32 v82, s72, v82
    v_xor_b32 v83, s73, v83
    v_xor_b32 v84, s70, v84
    v_xor_b32 v85, s71, v85
    v_xor_b32 v86, s72, v86
    v_xor_b32 v87, s73, v87
    v_xor_b32 v88, s70, v88
    v_xor_b32 v89, s71, v89
    v_xor_b32 v90, s72, v90
    v_xor_b32 v91, s73, v91
    v_xor_b32 v92, s70, v92
    v_xor_b32 v93, s71, v93
    v_xor_b32 v94, s72, v94
    v_xor_b32 v95, s73, v95
    v_or_b32 v3, v32, v33
    v_or3_b32 v3, v3, v34, v35
    v_or3_b32 v3, v3, v36, v37
    v_or3_b32 v3, v3, v38, v39
    v_or3_b32 v3, v3, v40, v41
    v_or3_b32 v3, v3, v42, v43
    v_or3_b32 v3, v3, v44, v45
    v_or3_b32 v3, v3, v46, v47
    v_or3_b32 v3, v3, v48, v49
    v_or3_b32 v3, v3, v50, v51
    v_or3_b32 v3, v3, v52, v53
    v_or3_b32 v3, v3, v54, v55
    v_or3_b32 v3, v3, v56, v57
    v_or3_b32 v3, v3, v58, v59
    v_or3_b32 v3, v3, v60, v61
    v_or3_b32 v3, v3, v62, v63
    v_or3_b32 v3, v3, v64, v65
    v_or3_b32 v3, v3, v66, v67
    v_or3_b32 v3, v3, v68, v69
    v_or3_b32 v3, v3, v70, v71
    v_or3_b32 v3, v3, v72, v73
    v_or3_b32 v3, v3, v74, v75
    v_or3_b32 v3, v3, v76, v77
    v_or3_b32 v3, v3, v78, v79
    v_or3_b32 v3, v3, v80, v81
    v_or3_b32 v3, v3, v82, v83
    v_or3_b32 v3, v3, v84, v85
    v_or3_b32 v3, v3, v86, v87
    v_or3_b32 v3, v3, v88, v89
    v_or3_b32 v3, v3, v90, v91
    v_or3_b32 v3, v3, v92, v93
    v_or3_b32 v3, v3, v94, v95
    v_and_b32 v3, 0xff, v3
    v_cmp_ne_u32 vcc, 0, v3
    s_nop 4
    s_cbranch_vccz Lok23
    s_add_u32 s47, s47, 1
    s_cmp_ge_u32 s47, 2000000
    s_cbranch_scc1 Lok23
    s_sleep 8
    s_mov_b64 s[62:63], vcc
    s_add_u32 s66, s66, 1
    s_cmp_lt_u32 s66, 24
    s_cbranch_scc1 L_gu2
    s_cmp_lg_u32 s66, 24
    s_cbranch_scc1 L_gu1
    s_mov_b64 exec, -1
Lre24:
    ds_read_b32 v3, v2 offset:56
    s_waitcnt lgkmcnt(0)
    v_cmp_gt_u32 vcc, 4, v3
    s_nop 4
    s_cbranch_vccz Lok24
    s_add_u32 s47, s47, 1
    s_cmp_ge_u32 s47, 2000000
    s_cbranch_scc1 Lok24
    s_sleep 1
    s_branch Lre24
Lok24:
    v_add_u32 v8, v14, v2
    ds_read_b128 v[16:19], v8 offset:6400
    ds_read_b128 v[20:23], v8 offset:7424
    v_mov_b32 v8, s46
    s_add_u32 s44, s50, 5888
    s_waitcnt lgkmcnt(0)
    v_perm_b32 v16, v16, v8, s53
    v_perm_b32 v17, v17, v8, s54
    v_perm_b32 v18, v18, v8, s55
    v_perm_b32 v19, v19, v8, s56
    v_perm_b32 v20, v20, v8, s53
    v_perm_b32 v21, v21, v8, s54
    v_perm_b32 v22, v22, v8, s55
    v_perm_b32 v23, v23, v8, s56
    buffer_store_dwordx4 v[16:19], v14, s[36:39], s44 offen sc1
    s_mov_b32 exec_hi, 0xffff
    buffer_store_dwordx4 v[20:23], v14, s[36:39], s44 offen offset:1024 sc1
L_gu1:
    s_add_u32 s65, s65, s68
    s_sub_u32 s68, 0, s68
    s_xor_b32 s73, s73, s67
L_gu2:
    s_mov_b64 exec, s[62:63]
    s_branch Lre23
Lok23:
    s_mov_b64 exec, -1
    s_mov_b64 exec, -1
    s_lshr_b32 s73, s46, 24
    s_cmp_lt_u32 s66, 24
    s_cselect_b32 s66, 1, 2
    v_add_f32 v32, v32, v48
    v_add_f32 v33, v33, v49
    v_add_f32 v34, v34, v50
    v_add_f32 v35, v35, v51
    v_add_f32 v36, v36, v52
    v_add_f32 v37, v37, v53
    v_add_f32 v38, v38, v54
    v_add_f32 v39, v39, v55
    v_add_f32 v40, v40, v56
    v_add_f32 v41, v41, v57
    v_add_f32 v42, v42, v58
    v_add_f32 v43, v43, v59
    v_add_f32 v44, v44, v60
    v_add_f32 v45, v45, v61
    v_add_f32 v46, v46, v62
    v_add_f32 v47, v47, v63
    v_add_f32 v32, v32, v40
    v_add_f32 v33, v33, v41
    v_add_f32 v34, v34, v42
    v_add_f32 v35, v35, v43
    v_add_f32 v36, v36, v44
    v_add_f32 v37, v37, v45
    v_add_f32 v38, v38, v46
    v_add_f32 v39, v39, v47
    v_add_f32 v32, v32, v36
    v_add_f32 v33, v33, v37
    v_add_f32 v34, v34, v38
    v_add_f32 v35, v35, v39
    v_add_f32 v64, v64, v80
    v_add_f32 v65, v65, v81
    v_add_f32 v66, v66, v82
    v_add_f32 v67, v67, v83
    v_add_f32 v68, v68, v84
    v_add_f32 v69, v69, v85
    v_add_f32 v70, v70, v86
    v_add_f32 v71, v71, v87
    v_add_f32 v72, v72, v88
    v_add_f32 v73, v73, v89
    v_add_f32 v74, v74, v90
    v_add_f32 v75, v75, v91
    v_add_f32 v76, v76, v92
    v_add_f32 v77, v77, v93
    v_add_f32 v78, v78, v94
    v_add_f32 v79, v79, v95
    v_add_f32 v64, v64, v72
    v_add_f32 v65, v65, v73
    v_add_f32 v66, v66, v74
    v_add_f32 v67, v67, v75
    v_add_f32 v68, v68, v76
    v_add_f32 v69, v69, v77
    v_add_f32 v70, v70, v78
    v_add_f32 v71, v71, v79
    v_add_f32 v64, v64, v68
    v_add_f32 v65, v65, v69
    v_add_f32 v66, v66, v70
    v_add_f32 v67, v67, v71
    v_mov_b32 v36, v32
    v_mov_b32 v37, v33
    v_mov_b32 v38, v34
    v_mov_b32 v39, v35
    v_permlane32_swap_b32 v32, v36
    v_permlane32_swap_b32 v33, v37
    v_permlane32_swap_b32 v34, v38
    v_permlane32_swap_b32 v35, v39
    v_add_f32 v32, v32, v36
    v_add_f32 v33, v33, v37
    v_add_f32 v34, v34, v38
    v_add_f32 v35, v35, v39
    v_cvt_pk_bf16_f32 v36, v32, v33
    v_cvt_pk_bf16_f32 v38, v34, v35
    v_lshlrev_b32 v32, 16, v36
    v_and_b32 v33, s48, v36
    v_lshlrev_b32 v34, 16, v38
    v_and_b32 v35, s48, v38
    v_mov_b32 v68, v64
    v_mov_b32 v69, v65
    v_mov_b32 v70, v66
    v_mov_b32 v71, v67
    v_permlane32_swap_b32 v64, v68
    v_permlane32_swap_b32 v65, v69
    v_permlane32_swap_b32 v66, v70
    v_permlane32_swap_b32 v67, v71
    v_add_f32 v64, v64, v68
    v_add_f32 v65, v65, v69
    v_add_f32 v66, v66, v70
    v_add_f32 v67, v67, v71
    v_cvt_pk_bf16_f32 v68, v64, v65
    v_cvt_pk_bf16_f32 v70, v66, v67
    v_lshlrev_b32 v64, 16, v68
    v_and_b32 v65, s48, v68
    v_lshlrev_b32 v66, 16, v70
    v_and_b32 v67, s48, v70
    s_mov_b32 s44, 0x3d372713
    s_mov_b32 s45, 0xc0135761
    v_mul_f32 v40, v32, v32
    v_mul_f32 v41, v33, v33
    v_mul_f32 v42, v34, v34
    v_mul_f32 v43, v35, v35
    v_fma_f32 v40, v40, s44, 1.0
    v_fma_f32 v41, v41, s44, 1.0
    v_fma_f32 v42, v42, s44, 1.0
    v_fma_f32 v43, v43, s44, 1.0
    v_mul_f32 v40, v40, v32
    v_mul_f32 v41, v41, v33
    v_mul_f32 v42, v42, v34
    v_mul_f32 v43, v43, v35
    v_mul_f32 v40, s45, v40
    v_mul_f32 v41, s45, v41
    v_mul_f32 v42, s45, v42
    v_mul_f32 v43, s45, v43
    v_exp_f32 v40, v40
    v_exp_f32 v41, v41
    v_exp_f32 v42, v42
    v_exp_f32 v43, v43
    v_add_f32 v40, 1.0, v40
    v_add_f32 v41, 1.0, v41
    v_add_f32 v42, 1.0, v42
    v_add_f32 v43, 1.0, v43
    v_rcp_f32 v40, v40
    v_rcp_f32 v41, v41
    v_rcp_f32 v42, v42
    v_rcp_f32 v43, v43
    v_mul_f32 v32, v32, v40
    v_mul_f32 v33, v33, v41
    v_mul_f32 v34, v34, v42
    v_mul_f32 v35, v35, v43
    v_cvt_pk_bf16_f32 v40, v32, v33
    v_cvt_pk_bf16_f32 v42, v34, v35
    v_lshlrev_b32 v32, 16, v40
    v_and_b32 v33, s48, v40
    v_lshlrev_b32 v34, 16, v42
    v_and_b32 v35, s48, v42
    v_mul_f32 v32, v32, v64
    v_mul_f32 v33, v33, v65
    v_mul_f32 v34, v34, v66
    v_mul_f32 v35, v35, v67
    v_cvt_pk_bf16_f32 v32, v32, v33
    v_cvt_pk_bf16_f32 v33, v34, v35
    v_bfe_u32 v8, v1, 3, 2
    v_lshl_add_u32 v8, v8, 6, v2
    v_and_b32 v9, 3, v1
    v_lshl_add_u32 v8, v9, 4, v8
    v_bfe_u32 v9, v1, 2, 1
    v_lshl_add_u32 v8, v9, 3, v8
    ds_write_b64 v8, v[32:33] offset:5120
    v_mov_b32 v3, s66
    s_mov_b64 exec, 1
    ds_add_u32 v2, v3 offset:52
    s_mov_b64 exec, -1
    v_and_b32 v9, 31, v1
    v_lshl_add_u32 v9, v9, 3, v2
Lre25:
    ds_read_b32 v3, v2 offset:44
    s_waitcnt lgkmcnt(0)
    v_cmp_gt_u32 vcc, 4, v3
    s_nop 4
    s_cbranch_vccz Lok25
    s_add_u32 s47, s47, 1
    s_cmp_ge_u32 s47, 2000000
    s_cbranch_scc1 Lok25
    s_sleep 8
    s_branch Lre25
Lok25:
    ds_read_b64 v[16:17], v9 offset:4736
    v_mov_b32 v8, s46
    s_waitcnt lgkmcnt(0)
    v_add_f32_dpp v17, v17, v17 row_ror:8 row_mask:0xf bank_mask:0xf
    v_mov_b32 v10, v17
    s_nop 1
    v_permlane16_swap_b32 v17, v10
    v_add_f32 v17, v17, v10
    v_mov_b32_dpp v18, v16 quad_perm:[1,1,3,3] row_mask:0xf bank_mask:0xf
    s_nop 0
    v_mov_b32_dpp v19, v17 quad_perm:[1,1,3,3] row_mask:0xf bank_mask:0xf
    v_add_u32 v16, 0x80, v16
    v_add_u32 v17, 0x80, v17
    v_add_u32 v18, 0x80, v18
    v_add_u32 v19, 0x80, v19
    v_perm_b32 v20, v16, v8, s53
    v_perm_b32 v21, v17, v8, s54
    v_perm_b32 v22, v18, v8, s55
    v_perm_b32 v23, v19, v8, s56
    v_lshlrev_b32 v10, 3, v1
    s_add_u32 s44, s50, 7936
    s_mov_b64 exec, 0x55
    buffer_store_dwordx4 v[20:23], v10, s[36:39], s44 offen sc1
    s_mov_b64 exec, -1
    v_lshrrev_b32 v8, 2, v1
    v_mul_u32_u24 v8, 8448, v8
    v_and_b32 v9, 3, v1
    v_lshl_add_u32 v15, v9, 4, v8
    v_lshl_add_u32 v24, v9, 4, v2
    ds_read_b32 v26, v24 offset:4736
    ds_read_b32 v27, v24 offset:4744
    s_mul_i32 s65, s57, 540672
    s_add_u32 s65, s65, 7936
Lre26:
    s_cmp_ge_i32 s51, 480
    s_cbranch_scc1 Lok26
    ds_read_b32 v3, v2 offset:0
    s_waitcnt lgkmcnt(0)
    v_readfirstlane_b32 s51, v3
    s_nop 1
    s_cmp_ge_i32 s51, 480
    s_cbranch_scc1 Lok26
    s_add_u32 s47, s47, 1
    s_cmp_ge_u32 s47, 2000000
    s_cbranch_scc1 Lok26
    s_sleep 8
    s_branch Lre26
Lok26:
Lre27:
    s_mov_b32 s45, s65
    buffer_load_dwordx4 v[32:35], v15, s[36:39], s45 offen sc1
    s_add_u32 s45, s45, 135168
    buffer_load_dwordx4 v[36:39], v15, s[36:39], s45 offen sc1
    s_add_u32 s45, s45, 135168
    buffer_load_dwordx4 v[40:43], v15, s[36:39], s45 offen sc1
    s_add_u32 s45, s45, 135168
    buffer_load_dwordx4 v[44:47], v15, s[36:39], s45 offen sc1
    s_add_u32 s45, s45, 135168
    s_waitcnt vmcnt(0)
Lck27:
    v_xor_b32 v32, s70, v32
    v_xor_b32 v33, s71, v33
    v_xor_b32 v34, s72, v34
    v_xor_b32 v35, s73, v35
    v_xor_b32 v36, s70, v36
    v_xor_b32 v37, s71, v37
    v_xor_b32 v38, s72, v38
    v_xor_b32 v39, s73, v39
    v_xor_b32 v40, s70, v40
    v_xor_b32 v41, s71, v41
    v_xor_b32 v42, s72, v42
    v_xor_b32 v43, s73, v43
    v_xor_b32 v44, s70, v44
    v_xor_b32 v45, s71, v45
    v_xor_b32 v46, s72, v46
    v_xor_b32 v47, s73, v47
    v_or_b32 v3, v32, v33
    v_or3_b32 v3, v3, v34, v35
    v_or3_b32 v3, v3, v36, v37
    v_or3_b32 v3, v3, v38, v39
    v_or3_b32 v3, v3, v40, v41
    v_or3_b32 v3, v3, v42, v43
    v_or3_b32 v3, v3, v44, v45
    v_or3_b32 v3, v3, v46, v47
    v_and_b32 v3, 0xff, v3
    v_cmp_ne_u32 vcc, 0, v3
    s_nop 4
    s_cbranch_vccz Lok27
    s_add_u32 s47, s47, 1
    s_cmp_ge_u32 s47, 2000000
    s_cbranch_scc1 Lok27
    s_sleep 8
    s_mov_b64 exec, vcc
    s_branch Lre27
Lok27:
    s_mov_b64 exec, -1
    s_waitcnt lgkmcnt(0)
    v_max_f32 v16, v32, v36
    v_max3_f32 v16, v16, v40, v44
    s_nop 1
    v_max_f32_dpp v16, v16, v16 row_ror:4 row_mask:0xf bank_mask:0xf
    s_nop 1
    v_max_f32_dpp v16, v16, v16 row_ror:8 row_mask:0xf bank_mask:0xf
    v_mov_b32 v10, v16
    s_nop 1
    v_permlane16_swap_b32 v16, v10
    v_max_f32 v16, v16, v10
    v_mov_b32 v10, v16
    s_nop 1
    v_permlane32_swap_b32 v16, v10
    v_max_f32 v16, v16, v10
    v_sub_f32 v8, v32, v16
    v_mul_f32 v8, s49, v8
    v_exp_f32 v8, v8
    s_nop 0
    v_mul_f32 v17, v8, v33
    v_sub_f32 v8, v36, v16
    v_mul_f32 v8, s49, v8
    v_exp_f32 v8, v8
    s_nop 0
    v_fmac_f32 v17, v8, v37
    v_sub_f32 v8, v40, v16
    v_mul_f32 v8, s49, v8
    v_exp_f32 v8, v8
    s_nop 0
    v_fmac_f32 v17, v8, v41
    v_sub_f32 v8, v44, v16
    v_mul_f32 v8, s49, v8
    v_exp_f32 v8, v8
    s_nop 0
    v_fmac_f32 v17, v8, v45
    s_nop 1
    v_add_f32_dpp v17, v17, v17 row_ror:4 row_mask:0xf bank_mask:0xf
    s_nop 1
    v_add_f32_dpp v17, v17, v17 row_ror:8 row_mask:0xf bank_mask:0xf
    v_mov_b32 v10, v17
    s_nop 1
    v_permlane16_swap_b32 v17, v10
    v_add_f32 v17, v17, v10
    v_mov_b32 v10, v17
    s_nop 1
    v_permlane32_swap_b32 v17, v10
    v_add_f32 v17, v17, v10
    v_rcp_f32 v17, v17
    v_sub_f32 v8, v26, v16
    v_mul_f32 v8, s49, v8
    v_exp_f32 v8, v8
    s_nop 0
    v_mul_f32 v20, v8, v17
    v_max_f32 v18, v34, v38
    v_max3_f32 v18, v18, v42, v46
    s_nop 1
    v_max_f32_dpp v18, v18, v18 row_ror:4 row_mask:0xf bank_mask:0xf
    s_nop 1
    v_max_f32_dpp v18, v18, v18 row_ror:8 row_mask:0xf bank_mask:0xf
    v_mov_b32 v10, v18
    s_nop 1
    v_permlane16_swap_b32 v18, v10
    v_max_f32 v18, v18, v10
    v_mov_b32 v10, v18
    s_nop 1
    v_permlane32_swap_b32 v18, v10
    v_max_f32 v18, v18, v10
    v_sub_f32 v8, v34, v18
    v_mul_f32 v8, s49, v8
    v_exp_f32 v8, v8
    s_nop 0
    v_mul_f32 v19, v8, v35
    v_sub_f32 v8, v38, v18
    v_mul_f32 v8, s49, v8
    v_exp_f32 v8, v8
    s_nop 0
    v_fmac_f32 v19, v8, v39
    v_sub_f32 v8, v42, v18
    v_mul_f32 v8, s49, v8
    v_exp_f32 v8, v8
    s_nop 0
    v_fmac_f32 v19, v8, v43
    v_sub_f32 v8, v46, v18
    v_mul_f32 v8, s49, v8
    v_exp_f32 v8, v8
    s_nop 0
    v_fmac_f32 v19, v8, v47
    s_nop 1
    v_add_f32_dpp v19, v19, v19 row_ror:4 row_mask:0xf bank_mask:0xf
    s_nop 1
    v_add_f32_dpp v19, v19, v19 row_ror:8 row_mask:0xf bank_mask:0xf
    v_mov_b32 v10, v19
    s_nop 1
    v_permlane16_swap_b32 v19, v10
    v_add_f32 v19, v19, v10
    v_mov_b32 v10, v19
    s_nop 1
    v_permlane32_swap_b32 v19, v10
    v_add_f32 v19, v19, v10
    v_rcp_f32 v19, v19
    v_sub_f32 v8, v27, v18
    v_mul_f32 v8, s49, v8
    v_exp_f32 v8, v8
    s_nop 0
    v_mul_f32 v21, v8, v19
    v_lshl_add_u32 v9, v9, 3, v2
    ds_write_b64 v9, v[20:21] offset:4992
    v_mov_b32 v3, 1
    s_mov_b64 exec, 1
    ds_add_u32 v2, v3 offset:48
    s_mov_b64 exec, -1
    v_lshrrev_b32 v8, 1, v1
    v_mul_u32_u24 v8, 8448, v8
    v_and_b32 v9, 1, v1
    v_lshlrev_b32 v9, 4, v9
    v_add_u32 v16, v9, v8
    v_lshl_add_u32 v15, v8, 3, v9
    s_lshl_b32 s44, s59, 5
    s_mul_i32 s65, s58, 8448
    s_lshl_b32 s67, s65, 5
    s_add_u32 s65, s65, s44
    s_add_u32 s67, s67, s44
    v_lshlrev_b32 v12, 16, v12
Lre28:
    s_cmp_ge_i32 s51, 672
    s_cbranch_scc1 Lok28
    ds_read_b32 v3, v2 offset:0
    s_waitcnt lgkmcnt(0)
    v_readfirstlane_b32 s51, v3
    s_nop 1
    s_cmp_ge_i32 s51, 672
    s_cbranch_scc1 Lok28
    s_add_u32 s47, s47, 1
    s_cmp_ge_u32 s47, 2000000
    s_cbranch_scc1 Lok28
    s_sleep 1
    s_branch Lre28
Lok28:
    buffer_load_dwordx4 v[36:39], v16, s[36:39], s67 offen offset:3072 sc1
    buffer_load_dwordx4 v[32:35], v15, s[36:39], s65 offen offset:2048 sc1
    s_barrier
    s_waitcnt vmcnt(0)
    s_branch Lck29
Lre29:
    buffer_load_dwordx4 v[36:39], v16, s[36:39], s67 offen offset:3072 sc1
    s_waitcnt vmcnt(0)
Lck29:
    v_xor_b32 v36, s70, v36
    v_xor_b32 v37, s71, v37
    v_xor_b32 v38, s72, v38
    v_xor_b32 v39, s73, v39
    v_or_b32 v3, v36, v37
    v_or3_b32 v3, v3, v38, v39
    v_and_b32 v3, 0xff, v3
    v_cmp_ne_u32 vcc, 0, v3
    s_nop 4
    s_cbranch_vccz Lok29
    s_add_u32 s47, s47, 1
    s_cmp_ge_u32 s47, 2000000
    s_cbranch_scc1 Lok29
    s_sleep 2
    s_mov_b64 exec, vcc
    s_branch Lre29
Lok29:
    s_mov_b64 exec, -1
    buffer_load_dwordx4 v[32:35], v15, s[36:39], s65 offen offset:2048 sc1
    v_permlane32_swap_b32 v36, v38
    v_add_f32 v36, v36, v38
    s_nop 1
    v_add_f32_dpp v36, v36, v36 row_ror:2 row_mask:0xf bank_mask:0xf
    s_nop 1
    v_add_f32_dpp v36, v36, v36 row_ror:4 row_mask:0xf bank_mask:0xf
    s_nop 1
    v_add_f32_dpp v36, v36, v36 row_ror:8 row_mask:0xf bank_mask:0xf
    v_mov_b32 v37, v36
    s_nop 1
    v_permlane16_swap_b32 v36, v37
    v_add_f32 v36, v36, v37
    v_cvt_pk_bf16_f32 v36, v36, v36
    v_lshlrev_b32 v36, 16, v36
    v_mul_f32 v8, s49, v36
    v_exp_f32 v8, -v8
    s_nop 0
    v_add_f32 v8, 1.0, v8
    v_rcp_f32 v8, v8
    s_nop 0
    v_mul_f32 v8, v8, v36
    v_cvt_pk_bf16_f32 v8, v8, v8
    v_lshlrev_b32 v8, 16, v8
    s_waitcnt vmcnt(0)
    s_branch Lck30
Lre30:
    buffer_load_dwordx4 v[32:35], v15, s[36:39], s65 offen offset:2048 sc1
    s_waitcnt vmcnt(0)
Lck30:
    v_xor_b32 v32, s70, v32
    v_xor_b32 v33, s71, v33
    v_xor_b32 v34, s72, v34
    v_xor_b32 v35, s73, v35
    v_or_b32 v3, v32, v33
    v_or3_b32 v3, v3, v34, v35
    v_and_b32 v3, 0xff, v3
    v_cmp_ne_u32 vcc, 0, v3
    s_nop 4
    s_cbranch_vccz Lok30
    s_add_u32 s47, s47, 1
    s_cmp_ge_u32 s47, 2000000
    s_cbranch_scc1 Lok30
    s_mov_b64 exec, vcc
    s_branch Lre30
Lok30:
    s_mov_b64 exec, -1
    v_permlane32_swap_b32 v32, v34
    v_add_f32 v32, v32, v34
    s_nop 1
    v_add_f32_dpp v32, v32, v32 row_ror:2 row_mask:0xf bank_mask:0xf
    s_nop 1
    v_add_f32_dpp v32, v32, v32 row_ror:4 row_mask:0xf bank_mask:0xf
    s_nop 1
    v_add_f32_dpp v32, v32, v32 row_ror:8 row_mask:0xf bank_mask:0xf
    v_mov_b32 v33, v32
    s_nop 1
    v_permlane16_swap_b32 v32, v33
    v_add_f32 v32, v32, v33
    v_cvt_pk_bf16_f32 v32, v32, v32
    v_lshlrev_b32 v32, 16, v32
    v_mul_f32 v8, v8, v32
    v_cvt_pk_bf16_f32 v8, v8, v8
    v_lshlrev_b32 v8, 16, v8
    v_add_f32 v8, v8, v12
    v_cvt_pk_bf16_f32 v8, v8, v8
    s_mov_b32 exec_lo, 3
    s_mov_b32 exec_hi, 3
    buffer_store_short v8, v13, s[32:35], s64 offen
    s_cmp_lg_u32 s2, 0
    s_cbranch_scc1 L_noep
    s_mov_b64 exec, 1
    v_mov_b32 v9, s46
    s_mov_b32 s44, 3145728
    buffer_store_dword v9, off, s[36:39], s44
L_noep:
    s_endpgm
L_consumer:
    s_sub_u32 s52, s3, 2
    v_lshrrev_b32 v4, 4, v1
    v_bfe_u32 v5, v1, 2, 2
    v_and_b32 v6, 3, v1
    v_and_b32 v7, 15, v1
    s_lshl_b32 s44, s52, 2
    v_add_u32 v8, s44, v2
    v_lshlrev_b32 v10, 10, v4
    v_lshl_add_u32 v10, v5, 7, v10
    v_lshl_add_u32 v10, v6, 3, v10
    s_lshl_b32 s44, s52, 5
    v_add_u32 v10, s44, v10
    v_lshl_add_u32 v11, v4, 4, v2
    s_and_b32 s44, s2, 3
    s_lshl_b32 s44, s44, 9
    v_add_u32 v12, s44, v11
    s_and_b32 s44, s59, 15
    s_lshl_b32 s44, s44, 7
    v_add_u32 v13, s44, v11
    v_lshlrev_b32 v14, 13, v4
    v_lshl_add_u32 v14, v5, 10, v14
    v_lshl_add_u32 v14, v6, 3, v14
    s_mul_i32 s44, s52, 224
    s_add_u32 s44, s44, 32768
    v_add_u32 v14, s44, v14
    v_lshlrev_b32 v15, 4, v4
    s_waitcnt lgkmcnt(0)
    s_barrier
    s_add_u32 s46, s46, 1
    v_mov_b32 v9, s46
Lre31:
    ds_read_b32 v3, v2 offset:32
    s_waitcnt lgkmcnt(0)
    v_cmp_gt_u32 vcc, 1, v3
    s_nop 4
    s_cbranch_vccz Lok31
    s_add_u32 s47, s47, 1
    s_cmp_ge_u32 s47, 2000000
    s_cbranch_scc1 Lok31
    s_sleep 1
    s_branch Lre31
Lok31:
    ds_read_b128 v[32:35], v12 offset:256
    ds_read_b128 v[36:39], v12 offset:320
    ds_read_b128 v[40:43], v12 offset:384
    ds_read_b128 v[44:47], v12 offset:448
    ds_read_b128 v[48:51], v12 offset:512
    ds_read_b128 v[52:55], v12 offset:576
    ds_read_b128 v[56:59], v12 offset:640
    ds_read_b128 v[60:63], v12 offset:704
    ds_read_b128 v[64:67], v13 offset:256
    ds_read_b128 v[68:71], v13 offset:320
Lre32:
    s_cmp_ge_i32 s51, 16
    s_cbranch_scc1 Lok32
    ds_read_b32 v3, v2 offset:0
    s_waitcnt lgkmcnt(0)
    v_readfirstlane_b32 s51, v3
    s_nop 1
    s_cmp_ge_i32 s51, 16
    s_cbranch_scc1 Lok32
    s_add_u32 s47, s47, 1
    s_cmp_ge_u32 s47, 2000000
    s_cbranch_scc1 Lok32
    s_sleep 1
    s_branch Lre32
Lok32:
    ds_read_b64_tr_b16 v[72:73], v10 offset:0
    ds_read_b64_tr_b16 v[74:75], v10 offset:512
    ds_read_b64_tr_b16 v[76:77], v10 offset:4096
    ds_read_b64_tr_b16 v[78:79], v10 offset:4608
    ds_read_b64_tr_b16 v[80:81], v10 offset:8192
    ds_read_b64_tr_b16 v[82:83], v10 offset:8704
    ds_read_b64_tr_b16 v[84:85], v10 offset:12288
    ds_read_b64_tr_b16 v[86:87], v10 offset:12800
    s_waitcnt lgkmcnt(0)
    v_mfma_f32_16x16x32_bf16 v[16:19], v[72:75], v[32:35], 0
    v_mfma_f32_16x16x32_bf16 v[16:19], v[76:79], v[36:39], v[16:19]
    v_mfma_f32_16x16x32_bf16 v[16:19], v[80:83], v[40:43], v[16:19]
    v_mfma_f32_16x16x32_bf16 v[16:19], v[84:87], v[44:47], v[16:19]
Lre33:
    s_cmp_ge_i32 s51, 32
    s_cbranch_scc1 Lok33
    ds_read_b32 v3, v2 offset:0
    s_waitcnt lgkmcnt(0)
    v_readfirstlane_b32 s51, v3
    s_nop 1
    s_cmp_ge_i32 s51, 32
    s_cbranch_scc1 Lok33
    s_add_u32 s47, s47, 1
    s_cmp_ge_u32 s47, 2000000
    s_cbranch_scc1 Lok33
    s_sleep 1
    s_branch Lre33
Lok33:
    ds_read_b64_tr_b16 v[88:89], v10 offset:16384
    ds_read_b64_tr_b16 v[90:91], v10 offset:16896
    ds_read_b64_tr_b16 v[92:93], v10 offset:20480
    ds_read_b64_tr_b16 v[94:95], v10 offset:20992
    ds_read_b64_tr_b16 v[96:97], v10 offset:24576
    ds_read_b64_tr_b16 v[98:99], v10 offset:25088
    ds_read_b64_tr_b16 v[100:101], v10 offset:28672
    ds_read_b64_tr_b16 v[102:103], v10 offset:29184
    s_waitcnt lgkmcnt(0)
    v_mfma_f32_16x16x32_bf16 v[16:19], v[88:91], v[48:51], v[16:19]
    v_mfma_f32_16x16x32_bf16 v[16:19], v[92:95], v[52:55], v[16:19]
    v_mfma_f32_16x16x32_bf16 v[16:19], v[96:99], v[56:59], v[16:19]
    v_mfma_f32_16x16x32_bf16 v[16:19], v[100:103], v[60:63], v[16:19]
    v_mov_b32 v3, 32
    ds_write_b32 v8, v3 offset:16
    s_nop 5
    v_add_u32 v16, 0x80, v16
    v_add_u32 v17, 0x80, v17
    v_add_u32 v18, 0x80, v18
    v_add_u32 v19, 0x80, v19
    v_perm_b32 v20, v16, v9, s53
    v_perm_b32 v21, v17, v9, s54
    v_perm_b32 v22, v18, v9, s55
    v_perm_b32 v23, v19, v9, s56
    s_lshl_b32 s44, s52, 6
    s_add_u32 s44, s44, s50
    s_add_u32 s44, s44, 7680
    s_mov_b32 exec_lo, 0x00010001
    s_mov_b32 exec_hi, 0x00010001
    buffer_store_dwordx4 v[20:23], v15, s[36:39], s44 offen sc1
    s_mov_b64 exec, -1
Lre34:
    s_cmp_ge_i32 s51, 64
    s_cbranch_scc1 Lok34
    ds_read_b32 v3, v2 offset:0
    s_waitcnt lgkmcnt(0)
    v_readfirstlane_b32 s51, v3
    s_nop 1
    s_cmp_ge_i32 s51, 64
    s_cbranch_scc1 Lok34
    s_add_u32 s47, s47, 1
    s_cmp_ge_u32 s47, 2000000
    s_cbranch_scc1 Lok34
    s_sleep 1
    s_branch Lre34
Lok34:
    ds_read_b64_tr_b16 v[72:73], v14 offset:0
    ds_read_b64_tr_b16 v[74:75], v14 offset:4096
    ds_read_b64_tr_b16 v[76:77], v14 offset:32
    ds_read_b64_tr_b16 v[78:79], v14 offset:4128
    ds_read_b64_tr_b16 v[80:81], v14 offset:64
    ds_read_b64_tr_b16 v[82:83], v14 offset:4160
    ds_read_b64_tr_b16 v[84:85], v14 offset:96
    ds_read_b64_tr_b16 v[86:87], v14 offset:4192
    ds_read_b64_tr_b16 v[88:89], v14 offset:128
    ds_read_b64_tr_b16 v[90:91], v14 offset:4224
    ds_read_b64_tr_b16 v[92:93], v14 offset:160
    ds_read_b64_tr_b16 v[94:95], v14 offset:4256
    ds_read_b64_tr_b16 v[96:97], v14 offset:192
    ds_read_b64_tr_b16 v[98:99], v14 offset:4288
    s_waitcnt lgkmcnt(0)
    v_mov_b32 v3, 64
    ds_write_b32 v8, v3 offset:16
    v_mfma_f32_16x16x32_bf16 v[128:131], v[72:75], v[64:67], 0
    v_mfma_f32_16x16x32_bf16 v[132:135], v[76:79], v[64:67], 0
    v_mfma_f32_16x16x32_bf16 v[136:139], v[80:83], v[64:67], 0
    v_mfma_f32_16x16x32_bf16 v[140:143], v[84:87], v[64:67], 0
    v_mfma_f32_16x16x32_bf16 v[144:147], v[88:91], v[64:67], 0
    v_mfma_f32_16x16x32_bf16 v[148:151], v[92:95], v[64:67], 0
    v_mfma_f32_16x16x32_bf16 v[152:155], v[96:99], v[64:67], 0
Lre35:
    s_cmp_ge_i32 s51, 96
    s_cbranch_scc1 Lok35
    ds_read_b32 v3, v2 offset:0
    s_waitcnt lgkmcnt(0)
    v_readfirstlane_b32 s51, v3
    s_nop 1
    s_cmp_ge_i32 s51, 96
    s_cbranch_scc1 Lok35
    s_add_u32 s47, s47, 1
    s_cmp_ge_u32 s47, 2000000
    s_cbranch_scc1 Lok35
    s_sleep 1
    s_branch Lre35
Lok35:
    ds_read_b64_tr_b16 v[72:73], v14 offset:32768
    ds_read_b64_tr_b16 v[74:75], v14 offset:36864
    ds_read_b64_tr_b16 v[76:77], v14 offset:32800
    ds_read_b64_tr_b16 v[78:79], v14 offset:36896
    ds_read_b64_tr_b16 v[80:81], v14 offset:32832
    ds_read_b64_tr_b16 v[82:83], v14 offset:36928
    ds_read_b64_tr_b16 v[84:85], v14 offset:32864
    ds_read_b64_tr_b16 v[86:87], v14 offset:36960
    ds_read_b64_tr_b16 v[88:89], v14 offset:32896
    ds_read_b64_tr_b16 v[90:91], v14 offset:36992
    ds_read_b64_tr_b16 v[92:93], v14 offset:32928
    ds_read_b64_tr_b16 v[94:95], v14 offset:37024
    ds_read_b64_tr_b16 v[96:97], v14 offset:32960
    ds_read_b64_tr_b16 v[98:99], v14 offset:37056
    s_waitcnt lgkmcnt(0)
    s_lshl2_add_u32 s60, s52, 96
    v_mov_b32 v3, s60
    ds_write_b32 v8, v3 offset:16
    v_mfma_f32_16x16x32_bf16 v[128:131], v[72:75], v[68:71], v[128:131]
    v_mfma_f32_16x16x32_bf16 v[132:135], v[76:79], v[68:71], v[132:135]
    v_mfma_f32_16x16x32_bf16 v[136:139], v[80:83], v[68:71], v[136:139]
    v_mfma_f32_16x16x32_bf16 v[140:143], v[84:87], v[68:71], v[140:143]
    v_mfma_f32_16x16x32_bf16 v[144:147], v[88:91], v[68:71], v[144:147]
    v_mfma_f32_16x16x32_bf16 v[148:151], v[92:95], v[68:71], v[148:151]
    v_mfma_f32_16x16x32_bf16 v[152:155], v[96:99], v[68:71], v[152:155]
    s_mul_i32 s45, s52, 448
    s_add_u32 s44, s45, s50
    s_add_u32 s44, s44, 4096
    v_lshl_add_u32 v15, v7, 6, v15
    v_xor_b32 v10, s74, v9
    v_add3_u32 v11, v15, s45, v2
    s_nop 4
    s_mov_b32 exec_lo, 131074
    s_mov_b32 exec_hi, 131074
    v_mov_b32 v128, v132
    v_mov_b32 v129, v133
    v_mov_b32 v130, v134
    v_mov_b32 v131, v135
    s_mov_b32 exec_lo, 262148
    s_mov_b32 exec_hi, 262148
    v_mov_b32 v128, v136
    v_mov_b32 v129, v137
    v_mov_b32 v130, v138
    v_mov_b32 v131, v139
    s_mov_b32 exec_lo, 524296
    s_mov_b32 exec_hi, 524296
    v_mov_b32 v128, v140
    v_mov_b32 v129, v141
    v_mov_b32 v130, v142
    v_mov_b32 v131, v143
    s_mov_b32 exec_lo, 1048592
    s_mov_b32 exec_hi, 1048592
    v_mov_b32 v128, v144
    v_mov_b32 v129, v145
    v_mov_b32 v130, v146
    v_mov_b32 v131, v147
    s_mov_b32 exec_lo, 2097184
    s_mov_b32 exec_hi, 2097184
    v_mov_b32 v128, v148
    v_mov_b32 v129, v149
    v_mov_b32 v130, v150
    v_mov_b32 v131, v151
    s_mov_b32 exec_lo, 4194368
    s_mov_b32 exec_hi, 4194368
    v_mov_b32 v128, v152
    v_mov_b32 v129, v153
    v_mov_b32 v130, v154
    v_mov_b32 v131, v155
    s_mov_b32 exec_lo, 0x007f007f
    s_mov_b32 exec_hi, 0x007f007f
    v_add_u32 v128, 0x80, v128
    v_add_u32 v129, 0x80, v129
    v_add_u32 v130, 0x80, v130
    v_add_u32 v131, 0x80, v131
    v_perm_b32 v128, v128, v10, s53
    v_perm_b32 v129, v129, v10, s54
    v_perm_b32 v130, v130, v10, s55
    v_perm_b32 v131, v131, v10, s56
    buffer_store_dwordx4 v[128:131], v15, s[36:39], s44 offen
    ds_write_b128 v11, v[128:131] offset:6400
    v_mov_b32 v3, 1
    s_mov_b64 exec, 1
    ds_add_u32 v2, v3 offset:56
    s_mov_b64 exec, -1
    v_and_b32 v10, 7, v1
    v_lshlrev_b32 v11, 1, v10
    v_xor_b32 v11, v11, v4
    v_lshlrev_b32 v11, 4, v11
    v_lshl_add_u32 v24, v7, 8, v11
    v_xor_b32 v25, 64, v24
    v_xor_b32 v26, 128, v24
    v_xor_b32 v27, 192, v24
    v_mul_u32_u24 v11, 272, v10
    v_lshl_add_u32 v11, v4, 4, v11
    v_add_u32 v11, v11, v2
    v_lshl_add_u32 v30, v4, 3, v10
    v_lshl_add_u32 v30, v30, 4, v2
    s_lshr_b32 s44, s52, 1
    s_lshl_b32 s44, s44, 9
    s_and_b32 s45, s52, 1
    s_lshl3_add_u32 s44, s45, s44
    v_add_u32 v29, s44, v30
    v_mov_b32 v28, 0xff800000
    s_mov_b32 s62, 0x3db504f3
Lre36:
    ds_read_b32 v3, v2 offset:36
    s_waitcnt lgkmcnt(0)
    v_cmp_gt_u32 vcc, 1, v3
    s_nop 4
    s_cbranch_vccz Lok36
    s_add_u32 s47, s47, 1
    s_cmp_ge_u32 s47, 2000000
    s_cbranch_scc1 Lok36
    s_sleep 2
    s_branch Lre36
Lok36:
    ds_read_b128 v[32:35], v11 offset:2304
    ds_read_b128 v[36:39], v11 offset:2368
    ds_read_b128 v[40:43], v11 offset:2432
    ds_read_b128 v[44:47], v11 offset:2496
L_qk:
    s_add_u32 s61, s60, 4
Lre37:
    s_cmp_ge_i32 s51, s61
    s_cbranch_scc1 Lok37
    ds_read_b32 v3, v2 offset:0
    s_waitcnt lgkmcnt(0)
    v_readfirstlane_b32 s51, v3
    s_nop 1
    s_cmp_ge_i32 s51, s61
    s_cbranch_scc1 Lok37
    s_add_u32 s47, s47, 1
    s_cmp_ge_u32 s47, 2000000
    s_cbranch_scc1 Lok37
    s_sleep 1
    s_branch Lre37
Lok37:
    s_lshl_b32 s44, s60, 10
    s_and_b32 s44, s44, 0x1ffff
    s_add_u32 s60, s60, 16
    v_add_u32 v10, s44, v24
    v_add_u32 v11, s44, v25
    v_add_u32 v12, s44, v26
    v_add_u32 v13, s44, v27
    ds_read_b128 v[48:51], v10
    ds_read_b128 v[52:55], v11
    ds_read_b128 v[56:59], v12
    ds_read_b128 v[60:63], v13
    s_min_u32 s44, s60, 352
    s_waitcnt lgkmcnt(0)
    v_mov_b32 v3, s44
    ds_write_b32 v8, v3 offset:16
    v_mfma_f32_16x16x32_bf16 v[16:19], v[48:51], v[32:35], 0
    v_mfma_f32_16x16x32_bf16 v[16:19], v[52:55], v[36:39], v[16:19]
    v_mfma_f32_16x16x32_bf16 v[16:19], v[56:59], v[40:43], v[16:19]
    v_mfma_f32_16x16x32_bf16 v[16:19], v[60:63], v[44:47], v[16:19]
    s_nop 7
    v_cvt_pk_bf16_f32 v20, v16, v17
    v_cvt_pk_bf16_f32 v22, v18, v19
    v_lshlrev_b32 v16, 16, v20
    v_and_b32 v17, s48, v20
    v_lshlrev_b32 v18, 16, v22
    v_and_b32 v19, s48, v22
    v_mul_f32 v16, s62, v16
    v_mul_f32 v17, s62, v17
    v_mul_f32 v18, s62, v18
    v_mul_f32 v19, s62, v19
    v_cvt_pk_bf16_f32 v20, v16, v17
    v_cvt_pk_bf16_f32 v21, v18, v19
    v_max3_f32 v28, v28, v16, v17
    v_max3_f32 v28, v28, v18, v19
    ds_write_b64 v29, v[20:21] offset:8192
    v_add_u32 v29, 1024, v29
    s_cmpk_lt_u32 s60, 352
    s_cbranch_scc1 L_qk
    v_mov_b32 v10, v28
    s_nop 1
    v_permlane16_swap_b32 v28, v10
    v_max_f32 v28, v28, v10
    v_mov_b32 v10, v28
    s_nop 1
    v_permlane32_swap_b32 v28, v10
    v_max_f32 v28, v28, v10
    v_cvt_pk_bf16_f32 v28, v28, v28
    v_lshlrev_b32 v28, 16, v28
    v_and_b32 v10, 7, v1
    v_lshl_add_u32 v11, v10, 2, v2
    s_lshl_b32 s44, s52, 5
    v_add_u32 v12, s44, v11
    ds_write_b32 v12, v28 offset:4608
    v_mov_b32 v3, 1
    s_mov_b64 exec, 1
    ds_add_u32 v2, v3 offset:40
    s_mov_b64 exec, -1
    v_lshl_add_u32 v13, v1, 4, v2
    s_lshl_b32 s44, s52, 12
    v_add_u32 v13, s44, v13
Lre38:
    ds_read_b32 v3, v2 offset:40
    s_waitcnt lgkmcnt(0)
    v_cmp_gt_u32 vcc, 4, v3
    s_nop 4
    s_cbranch_vccz Lok38
    s_add_u32 s47, s47, 1
    s_cmp_ge_u32 s47, 2000000
    s_cbranch_scc1 Lok38
    s_sleep 1
    s_branch Lre38
Lok38:
    ds_read_b32 v16, v11 offset:4608
    ds_read_b32 v17, v11 offset:4640
    ds_read_b32 v18, v11 offset:4672
    ds_read_b32 v19, v11 offset:4704
    ds_read_b128 v[32:35], v13 offset:8192
    ds_read_b128 v[36:39], v13 offset:9216
    ds_read_b128 v[40:43], v13 offset:10240
    ds_read_b128 v[44:47], v13 offset:11264
    s_waitcnt lgkmcnt(0)
    v_max_f32 v16, v16, v17
    v_max3_f32 v16, v16, v18, v19
    v_mul_f32 v18, s49, v16
    v_lshlrev_b32 v48, 16, v32
    v_and_b32 v49, s48, v32
    v_lshlrev_b32 v50, 16, v33
    v_and_b32 v51, s48, v33
    v_lshlrev_b32 v52, 16, v34
    v_and_b32 v53, s48, v34
    v_lshlrev_b32 v54, 16, v35
    v_and_b32 v55, s48, v35
    v_lshlrev_b32 v56, 16, v36
    v_and_b32 v57, s48, v36
    v_lshlrev_b32 v58, 16, v37
    v_and_b32 v59, s48, v37
    v_lshlrev_b32 v60, 16, v38
    v_and_b32 v61, s48, v38
    v_lshlrev_b32 v62, 16, v39
    v_and_b32 v63, s48, v39
    v_lshlrev_b32 v64, 16, v40
    v_and_b32 v65, s48, v40
    v_lshlrev_b32 v66, 16, v41
    v_and_b32 v67, s48, v41
    v_lshlrev_b32 v68, 16, v42
    v_and_b32 v69, s48, v42
    v_lshlrev_b32 v70, 16, v43
    v_and_b32 v71, s48, v43
    v_lshlrev_b32 v72, 16, v44
    v_and_b32 v73, s48, v44
    v_lshlrev_b32 v74, 16, v45
    v_and_b32 v75, s48, v45
    v_lshlrev_b32 v76, 16, v46
    v_and_b32 v77, s48, v46
    v_lshlrev_b32 v78, 16, v47
    v_and_b32 v79, s48, v47
    v_fma_f32 v48, v48, s49, -v18
    v_fma_f32 v49, v49, s49, -v18
    v_fma_f32 v50, v50, s49, -v18
    v_fma_f32 v51, v51, s49, -v18
    v_fma_f32 v52, v52, s49, -v18
    v_fma_f32 v53, v53, s49, -v18
    v_fma_f32 v54, v54, s49, -v18
    v_fma_f32 v55, v55, s49, -v18
    v_fma_f32 v56, v56, s49, -v18
    v_fma_f32 v57, v57, s49, -v18
    v_fma_f32 v58, v58, s49, -v18
    v_fma_f32 v59, v59, s49, -v18
    v_fma_f32 v60, v60, s49, -v18
    v_fma_f32 v61, v61, s49, -v18
    v_fma_f32 v62, v62, s49, -v18
    v_fma_f32 v63, v63, s49, -v18
    v_fma_f32 v64, v64, s49, -v18
    v_fma_f32 v65, v65, s49, -v18
    v_fma_f32 v66, v66, s49, -v18
    v_fma_f32 v67, v67, s49, -v18
    v_fma_f32 v68, v68, s49, -v18
    v_fma_f32 v69, v69, s49, -v18
    v_fma_f32 v70, v70, s49, -v18
    v_fma_f32 v71, v71, s49, -v18
    v_fma_f32 v72, v72, s49, -v18
    v_fma_f32 v73, v73, s49, -v18
    v_fma_f32 v74, v74, s49, -v18
    v_fma_f32 v75, v75, s49, -v18
    v_fma_f32 v76, v76, s49, -v18
    v_fma_f32 v77, v77, s49, -v18
    v_fma_f32 v78, v78, s49, -v18
    v_fma_f32 v79, v79, s49, -v18
    v_exp_f32 v48, v48
    v_exp_f32 v49, v49
    v_exp_f32 v50, v50
    v_exp_f32 v51, v51
    v_exp_f32 v52, v52
    v_exp_f32 v53, v53
    v_exp_f32 v54, v54
    v_exp_f32 v55, v55
    v_exp_f32 v56, v56
    v_exp_f32 v57, v57
    v_exp_f32 v58, v58
    v_exp_f32 v59, v59
    v_exp_f32 v60, v60
    v_exp_f32 v61, v61
    v_exp_f32 v62, v62
    v_exp_f32 v63, v63
    v_exp_f32 v64, v64
    v_exp_f32 v65, v65
    v_exp_f32 v66, v66
    v_exp_f32 v67, v67
    v_exp_f32 v68, v68
    v_exp_f32 v69, v69
    v_exp_f32 v70, v70
    v_exp_f32 v71, v71
    v_exp_f32 v72, v72
    v_exp_f32 v73, v73
    v_exp_f32 v74, v74
    v_exp_f32 v75, v75
    v_exp_f32 v76, v76
    v_exp_f32 v77, v77
    v_exp_f32 v78, v78
    v_exp_f32 v79, v79
    v_cvt_pk_bf16_f32 v32, v48, v49
    v_cvt_pk_bf16_f32 v33, v50, v51
    v_cvt_pk_bf16_f32 v34, v52, v53
    v_cvt_pk_bf16_f32 v35, v54, v55
    v_cvt_pk_bf16_f32 v36, v56, v57
    v_cvt_pk_bf16_f32 v37, v58, v59
    v_cvt_pk_bf16_f32 v38, v60, v61
    v_cvt_pk_bf16_f32 v39, v62, v63
    v_cvt_pk_bf16_f32 v40, v64, v65
    v_cvt_pk_bf16_f32 v41, v66, v67
    v_cvt_pk_bf16_f32 v42, v68, v69
    v_cvt_pk_bf16_f32 v43, v70, v71
    v_cvt_pk_bf16_f32 v44, v72, v73
    v_cvt_pk_bf16_f32 v45, v74, v75
    v_cvt_pk_bf16_f32 v46, v76, v77
    v_cvt_pk_bf16_f32 v47, v78, v79
    ds_write_b128 v13, v[32:35] offset:8192
    ds_write_b128 v13, v[36:39] offset:9216
    ds_write_b128 v13, v[40:43] offset:10240
    ds_write_b128 v13, v[44:47] offset:11264
    v_add_f32 v48, v48, v64
    v_add_f32 v49, v49, v65
    v_add_f32 v50, v50, v66
    v_add_f32 v51, v51, v67
    v_add_f32 v52, v52, v68
    v_add_f32 v53, v53, v69
    v_add_f32 v54, v54, v70
    v_add_f32 v55, v55, v71
    v_add_f32 v56, v56, v72
    v_add_f32 v57, v57, v73
    v_add_f32 v58, v58, v74
    v_add_f32 v59, v59, v75
    v_add_f32 v60, v60, v76
    v_add_f32 v61, v61, v77
    v_add_f32 v62, v62, v78
    v_add_f32 v63, v63, v79
    v_add_f32 v48, v48, v56
    v_add_f32 v49, v49, v57
    v_add_f32 v50, v50, v58
    v_add_f32 v51, v51, v59
    v_add_f32 v52, v52, v60
    v_add_f32 v53, v53, v61
    v_add_f32 v54, v54, v62
    v_add_f32 v55, v55, v63
    v_add_f32 v48, v48, v52
    v_add_f32 v49, v49, v53
    v_add_f32 v50, v50, v54
    v_add_f32 v51, v51, v55
    v_add_f32 v48, v48, v50
    v_add_f32 v49, v49, v51
    v_add_f32 v17, v48, v49
    s_nop 1
    v_add_f32_dpp v17, v17, v17 row_ror:8 row_mask:0xf bank_mask:0xf
    v_mov_b32 v19, v17
    s_nop 1
    v_permlane16_swap_b32 v17, v19
    v_add_f32 v17, v17, v19
    v_mov_b32 v19, v17
    s_nop 1
    v_permlane32_swap_b32 v17, v19
    v_add_f32 v17, v17, v19
    v_lshl_add_u32 v11, v10, 3, v2
    s_lshl_b32 s44, s52, 6
    v_add_u32 v11, s44, v11
    ds_write_b64 v11, v[16:17] offset:4736
    v_mov_b32 v3, 1
    s_mov_b64 exec, 1
    ds_add_u32 v2, v3 offset:44
    s_mov_b64 exec, -1
    v_and_b32 v11, 1, v4
    v_lshlrev_b32 v11, 3, v11
    v_lshl_add_u32 v11, v5, 1, v11
    v_lshrrev_b32 v12, 1, v6
    v_xor_b32 v11, v11, v12
    v_and_b32 v12, 1, v6
    v_lshlrev_b32 v12, 3, v12
    v_lshl_add_u32 v12, v5, 8, v12
    s_lshl_b32 s44, s52, 2
    v_xor_b32 v13, s44, v11
    v_lshl_add_u32 v13, v13, 4, v12
    v_lshl_add_u32 v24, v4, 10, v13
    v_xor_b32 v25, 32, v24
    v_lshl_add_u32 v26, v4, 4, v2
    v_lshl_add_u32 v27, v6, 8, v26
    v_and_b32 v11, 1, v4
    v_lshl_add_u32 v11, v11, 3, v2
    v_lshl_add_u32 v11, v7, 4, v11
    s_lshl_b32 s44, s52, 8
    v_add_u32 v31, s44, v11
    s_add_u32 s69, s50, s44
    v_lshlrev_b32 v15, 4, v7
    v_lshlrev_b32 v28, 6, v7
    v_lshl_add_u32 v28, v4, 4, v28
    v_mul_u32_u24 v29, 8448, v4
    v_add_u32 v29, v29, v15
    s_lshl_b32 s44, s52, 9
    s_add_u32 s64, s50, s44
    s_lshl2_add_u32 s65, s57, s52
    s_mul_i32 s65, s65, 135168
    s_and_b32 s44, s59, 7
    s_lshl_b32 s44, s44, 8
    s_add_u32 s65, s65, s44
    s_add_u32 s66, s65, 33792
    s_add_u32 s67, s65, 67584
    s_add_u32 s68, s65, 101376
    v_and_b32 v11, 1, v1
    v_lshlrev_b32 v11, 4, v11
    v_mov_b32 v12, 0x3f80
    v_lshlrev_b32 v12, v11, v12
    v_bfe_u32 v11, v1, 1, 2
    v_cmp_eq_u32 vcc, 0, v11
    s_nop 1
    v_cndmask_b32 v64, 0, v12, vcc
    v_cmp_eq_u32 vcc, 1, v11
    s_nop 1
    v_cndmask_b32 v65, 0, v12, vcc
    v_cmp_eq_u32 vcc, 2, v11
    s_nop 1
    v_cndmask_b32 v66, 0, v12, vcc
    v_cmp_eq_u32 vcc, 3, v11
    s_nop 1
    v_cndmask_b32 v67, 0, v12, vcc
    v_mov_b32 v16, 0
    v_mov_b32 v17, 0
    v_mov_b32 v18, 0
    v_mov_b32 v19, 0
    v_mov_b32 v20, 0
    v_mov_b32 v21, 0
    v_mov_b32 v22, 0
    v_mov_b32 v23, 0
    s_movk_i32 s60, 352
Lre39:
    ds_read_b32 v3, v2 offset:44
    s_waitcnt lgkmcnt(0)
    v_cmp_gt_u32 vcc, 4, v3
    s_nop 4
    s_cbranch_vccz Lok39
    s_add_u32 s47, s47, 1
    s_cmp_ge_u32 s47, 2000000
    s_cbranch_scc1 Lok39
    s_sleep 1
    s_branch Lre39
Lok39:
L_pv:
    ds_read_b128 v[40:43], v30 offset:8192
    v_add_u32 v30, 512, v30
    s_lshl_b32 s44, s60, 10
    s_and_b32 s44, s44, 0x1ffff
    s_add_u32 s60, s60, 8
    v_add_u32 v10, s44, v24
    v_add_u32 v11, s44, v25
    s_cmpk_lg_u32 s60, 608
    s_cbranch_scc1 L_pvn
Lre40:
    ds_read_b32 v3, v2 offset:52
    s_waitcnt lgkmcnt(0)
    v_cmp_gt_u32 vcc, 1, v3
    s_nop 4
    s_cbranch_vccz Lok40
    s_add_u32 s47, s47, 1
    s_cmp_ge_u32 s47, 2000000
    s_cbranch_scc1 Lok40
    s_sleep 1
    s_branch Lre40
Lok40:
    v_readfirstlane_b32 s63, v3
Lre41:
    ds_read_b32 v3, v2 offset:48
    s_waitcnt lgkmcnt(0)
    v_cmp_gt_u32 vcc, 1, v3
    s_nop 4
    s_cbranch_vccz Lok41
    s_add_u32 s47, s47, 1
    s_cmp_ge_u32 s47, 2000000
    s_cbranch_scc1 Lok41
    s_sleep 1
    s_branch Lre41
Lok41:
    v_and_b32 v12, 7, v1
    v_lshl_add_u32 v12, v12, 2, v2
    ds_read_b32 v44, v12 offset:4992
    ds_read_b128 v[48:51], v26 offset:5120
    ds_read_b128 v[52:55], v26 offset:5184
    ds_read_b128 v[56:59], v26 offset:5248
    ds_read_b128 v[60:63], v26 offset:5312
L_pvn:
Lre42:
    s_cmp_ge_i32 s51, s60
    s_cbranch_scc1 Lok42
    ds_read_b32 v3, v2 offset:0
    s_waitcnt lgkmcnt(0)
    v_readfirstlane_b32 s51, v3
    s_nop 1
    s_cmp_ge_i32 s51, s60
    s_cbranch_scc1 Lok42
    s_add_u32 s47, s47, 1
    s_cmp_ge_u32 s47, 2000000
    s_cbranch_scc1 Lok42
    s_branch Lre42
Lok42:
    ds_read_b64_tr_b16 v[32:33], v10 offset:0
    ds_read_b64_tr_b16 v[34:35], v10 offset:4096
    ds_read_b64_tr_b16 v[36:37], v11 offset:0
    ds_read_b64_tr_b16 v[38:39], v11 offset:4096
    s_waitcnt lgkmcnt(0)
    v_mfma_f32_16x16x32_bf16 v[16:19], v[32:35], v[40:43], v[16:19]
    v_mfma_f32_16x16x32_bf16 v[20:23], v[36:39], v[40:43], v[20:23]
    v_mov_b32 v3, s60
    ds_write_b32 v8, v3 offset:16
    s_cmpk_lt_u32 s60, 608
    s_cbranch_scc1 L_pv
    s_nop 2
    v_mul_f32 v16, v16, v44
    v_mul_f32 v17, v17, v44
    v_mul_f32 v18, v18, v44
    v_mul_f32 v19, v19, v44
    v_mul_f32 v20, v20, v44
    v_mul_f32 v21, v21, v44
    v_mul_f32 v22, v22, v44
    v_mul_f32 v23, v23, v44
    v_cvt_pk_bf16_f32 v32, v16, v17
    v_cvt_pk_bf16_f32 v33, v18, v19
    v_cvt_pk_bf16_f32 v34, v20, v21
    v_cvt_pk_bf16_f32 v35, v22, v23
    v_min_u32 v32, -2, v32
    v_min_u32 v33, -2, v33
    v_min_u32 v34, -2, v34
    v_min_u32 v35, -2, v35
    s_mov_b32 exec_lo, 0x00ff00ff
    s_mov_b32 exec_hi, 0x00ff00ff
    buffer_store_dwordx4 v[32:35], v28, s[36:39], s64 offen sc1
    s_mov_b64 exec, -1
    v_add_u32 v10, 98304, v24
    v_add_u32 v11, 98304, v25
Lre43:
    s_cmp_ge_i32 s51, 636
    s_cbranch_scc1 Lok43
    ds_read_b32 v3, v2 offset:0
    s_waitcnt lgkmcnt(0)
    v_readfirstlane_b32 s51, v3
    s_nop 1
    s_cmp_ge_i32 s51, 636
    s_cbranch_scc1 Lok43
    s_add_u32 s47, s47, 1
    s_cmp_ge_u32 s47, 2000000
    s_cbranch_scc1 Lok43
    s_branch Lre43
Lok43:
Lre44:
    s_cmp_ge_i32 s51, 640
    s_cbranch_scc1 Lok44
    ds_read_b32 v3, v2 offset:0
    s_waitcnt lgkmcnt(0)
    v_readfirstlane_b32 s51, v3
    s_nop 1
    s_cmp_ge_i32 s51, 640
    s_cbranch_scc1 Lok44
    s_add_u32 s47, s47, 1
    s_cmp_ge_u32 s47, 2000000
    s_cbranch_scc1 Lok44
    s_branch Lre44
Lok44:
    ds_read_b64_tr_b16 v[72:73], v10 offset:0
    ds_read_b64_tr_b16 v[74:75], v10 offset:4096
    ds_read_b64_tr_b16 v[76:77], v11 offset:0
    ds_read_b64_tr_b16 v[78:79], v11 offset:4096
    ds_read_b64_tr_b16 v[80:81], v10 offset:8192
    ds_read_b64_tr_b16 v[82:83], v10 offset:12288
    ds_read_b64_tr_b16 v[84:85], v11 offset:8192
    ds_read_b64_tr_b16 v[86:87], v11 offset:12288
    ds_read_b64_tr_b16 v[88:89], v10 offset:16384
    ds_read_b64_tr_b16 v[90:91], v10 offset:20480
    ds_read_b64_tr_b16 v[92:93], v11 offset:16384
    ds_read_b64_tr_b16 v[94:95], v11 offset:20480
    ds_read_b64_tr_b16 v[96:97], v10 offset:24576
    ds_read_b64_tr_b16 v[98:99], v10 offset:28672
    ds_read_b64_tr_b16 v[100:101], v11 offset:24576
    ds_read_b64_tr_b16 v[102:103], v11 offset:28672
    s_waitcnt lgkmcnt(0)
    v_mfma_f32_16x16x32_bf16 v[104:107], v[48:51], v[72:75], 0
    v_mfma_f32_16x16x32_bf16 v[108:111], v[48:51], v[76:79], 0
    v_mfma_f32_16x16x32_bf16 v[104:107], v[52:55], v[80:83], v[104:107]
    v_mfma_f32_16x16x32_bf16 v[108:111], v[52:55], v[84:87], v[108:111]
    v_mfma_f32_16x16x32_bf16 v[104:107], v[56:59], v[88:91], v[104:107]
    v_mfma_f32_16x16x32_bf16 v[108:111], v[56:59], v[92:95], v[108:111]
    v_mfma_f32_16x16x32_bf16 v[104:107], v[60:63], v[96:99], v[104:107]
    v_mfma_f32_16x16x32_bf16 v[108:111], v[60:63], v[100:103], v[108:111]
    s_nop 6
    v_perm_b32 v68, v104, v9, s53
    v_perm_b32 v69, v104, v9, s54
    v_perm_b32 v70, v108, v9, s55
    v_perm_b32 v71, v108, v9, s56
    s_mov_b64 exec, 0xffff
    buffer_store_dwordx4 v[68:71], v15, s[36:39], s69 offen offset:3072 sc1
    s_mov_b64 exec, -1
Lre45:
    s_cmp_ge_i32 s51, 652
    s_cbranch_scc1 Lok45
    ds_read_b32 v3, v2 offset:0
    s_waitcnt lgkmcnt(0)
    v_readfirstlane_b32 s51, v3
    s_nop 1
    s_cmp_ge_i32 s51, 652
    s_cbranch_scc1 Lok45
    s_add_u32 s47, s47, 1
    s_cmp_ge_u32 s47, 2000000
    s_cbranch_scc1 Lok45
    s_branch Lre45
Lok45:
    buffer_load_dwordx4 v[136:139], v29, s[36:39], s65 offen sc1
    buffer_load_dwordx4 v[140:143], v29, s[36:39], s66 offen sc1
    buffer_load_dwordx4 v[144:147], v29, s[36:39], s67 offen sc1
    buffer_load_dwordx4 v[148:151], v29, s[36:39], s68 offen sc1
Lre46:
    s_cmp_ge_i32 s51, 672
    s_cbranch_scc1 Lok46
    ds_read_b32 v3, v2 offset:0
    s_waitcnt lgkmcnt(0)
    v_readfirstlane_b32 s51, v3
    s_nop 1
    s_cmp_ge_i32 s51, 672
    s_cbranch_scc1 Lok46
    s_add_u32 s47, s47, 1
    s_cmp_ge_u32 s47, 2000000
    s_cbranch_scc1 Lok46
    s_branch Lre46
Lok46:
    ds_read_b64_tr_b16 v[72:73], v24 offset:0
    ds_read_b64_tr_b16 v[74:75], v24 offset:4096
    ds_read_b64_tr_b16 v[76:77], v25 offset:0
    ds_read_b64_tr_b16 v[78:79], v25 offset:4096
    ds_read_b64_tr_b16 v[80:81], v24 offset:8192
    ds_read_b64_tr_b16 v[82:83], v24 offset:12288
    ds_read_b64_tr_b16 v[84:85], v25 offset:8192
    ds_read_b64_tr_b16 v[86:87], v25 offset:12288
    ds_read_b64_tr_b16 v[88:89], v24 offset:16384
    ds_read_b64_tr_b16 v[90:91], v24 offset:20480
    ds_read_b64_tr_b16 v[92:93], v25 offset:16384
    ds_read_b64_tr_b16 v[94:95], v25 offset:20480
    ds_read_b64_tr_b16 v[96:97], v24 offset:24576
    ds_read_b64_tr_b16 v[98:99], v24 offset:28672
    ds_read_b64_tr_b16 v[100:101], v25 offset:24576
    ds_read_b64_tr_b16 v[102:103], v25 offset:28672
    s_waitcnt vmcnt(0)
    s_branch Lck47
Lre47:
    buffer_load_dwordx4 v[136:139], v29, s[36:39], s65 offen sc1
    buffer_load_dwordx4 v[140:143], v29, s[36:39], s66 offen sc1
    buffer_load_dwordx4 v[144:147], v29, s[36:39], s67 offen sc1
    buffer_load_dwordx4 v[148:151], v29, s[36:39], s68 offen sc1
    s_waitcnt vmcnt(0)
Lck47:
    v_max3_u32 v3, v136, v137, v138
    v_max3_u32 v3, v3, v139, v140
    v_max3_u32 v3, v3, v141, v142
    v_max3_u32 v3, v3, v143, v144
    v_max3_u32 v3, v3, v145, v146
    v_max3_u32 v3, v3, v147, v148
    v_max3_u32 v3, v3, v149, v150
    v_max_u32 v3, v3, v151
    v_cmp_eq_u32 vcc, -1, v3
    s_nop 4
    s_cbranch_vccz Lok47
    s_add_u32 s47, s47, 1
    s_cmp_ge_u32 s47, 2000000
    s_cbranch_scc1 Lok47
    s_sleep 2
    s_mov_b64 exec, vcc
    s_branch Lre47
Lok47:
    s_mov_b64 exec, -1
    v_mfma_f32_16x16x32_bf16 v[16:19], v[64:67], v[136:139], 0
    v_mfma_f32_16x16x32_bf16 v[16:19], v[64:67], v[140:143], v[16:19]
    v_mfma_f32_16x16x32_bf16 v[16:19], v[64:67], v[144:147], v[16:19]
    v_mfma_f32_16x16x32_bf16 v[16:19], v[64:67], v[148:151], v[16:19]
    s_nop 7
    v_cvt_pk_bf16_f32 v20, v16, v17
    v_cvt_pk_bf16_f32 v21, v18, v19
    ds_write_b64 v31, v[20:21] offset:5376
    s_waitcnt lgkmcnt(0)
    s_barrier
    ds_read_b128 v[48:51], v27 offset:5376
    ds_read_b128 v[52:55], v27 offset:5440
    ds_read_b128 v[56:59], v27 offset:5504
    ds_read_b128 v[60:63], v27 offset:5568
    s_waitcnt lgkmcnt(3)
    v_mfma_f32_16x16x32_bf16 v[104:107], v[48:51], v[72:75], 0
    v_mfma_f32_16x16x32_bf16 v[108:111], v[48:51], v[76:79], 0
    s_waitcnt lgkmcnt(2)
    v_mfma_f32_16x16x32_bf16 v[104:107], v[52:55], v[80:83], v[104:107]
    v_mfma_f32_16x16x32_bf16 v[108:111], v[52:55], v[84:87], v[108:111]
    s_waitcnt lgkmcnt(1)
    v_mfma_f32_16x16x32_bf16 v[104:107], v[56:59], v[88:91], v[104:107]
    v_mfma_f32_16x16x32_bf16 v[108:111], v[56:59], v[92:95], v[108:111]
    s_waitcnt lgkmcnt(0)
    v_mfma_f32_16x16x32_bf16 v[104:107], v[60:63], v[96:99], v[104:107]
    v_mfma_f32_16x16x32_bf16 v[108:111], v[60:63], v[100:103], v[108:111]
    s_mov_b64 exec, 0xffff
    s_cmp_eq_u32 s63, 1
    s_nop 4
    v_add_f32 v104, v104, v105
    v_add_f32 v106, v106, v107
    v_add_f32 v108, v108, v109
    v_add_f32 v110, v110, v111
    v_add_f32 v104, v104, v106
    v_add_f32 v108, v108, v110
    v_perm_b32 v68, v104, v9, s53
    v_perm_b32 v70, v108, v9, s55
    s_cbranch_scc0 L_far
    buffer_store_dwordx4 v[68:71], v15, s[36:39], s69 offen offset:2048
    s_endpgm
L_far:
    buffer_store_dwordx4 v[68:71], v15, s[36:39], s69 offen offset:2048 sc1
L_end:
    s_endpgm
.section .rodata,"a"
.p2align 6
.amdhsa_kernel recurrent_scan__gqa_block_cached__glu_gated_geglu__decode_kernel
  .amdhsa_next_free_vgpr 168
  .amdhsa_next_free_sgpr 102
  .amdhsa_accum_offset 168
  .amdhsa_group_segment_fixed_size 0
  .amdhsa_kernarg_size 96
  .amdhsa_user_sgpr_count 2
  .amdhsa_user_sgpr_kernarg_segment_ptr 1
  .amdhsa_system_sgpr_workgroup_id_x 1
.end_amdhsa_kernel
```
